```python
import torch

def _softmax(x, axis=-1):
    return torch.softmax(x, dim=axis)
def _gelu(x):
    return torch.nn.functional.gelu(x, approximate="tanh")
def _silu(x):
    return torch.nn.functional.silu(x)
def _sigmoid(x):
    return torch.sigmoid(x)
def _layernorm(x, axis=-1, eps=1e-5):
    m = x.mean(dim=axis, keepdim=True)
    v = x.var(dim=axis, keepdim=True, unbiased=False)
    return (x - m) / torch.sqrt(v + eps)
def _scatter_add(tgt, idx, src, axis=0):
    return tgt.clone().index_add_(axis, idx, src)
def _segment_sum(src, seg, n):
    out = torch.zeros((n,) + src.shape[1:], dtype=src.dtype)
    return out.index_add_(0, seg, src)
def _pad(x, pw):
    flat = tuple(v for pair in reversed(pw) for v in pair)
    return torch.nn.functional.pad(x, flat)

kernel_name = 'standalone__gqa_softmax__near_ridge'

def setup_inputs():

    _w = (lambda a: (lambda t: t.to(torch.bfloat16) if t.is_floating_point() else t)(torch.as_tensor(a)))
    B, Hq, Hkv, Sq, Sk, D = 16, 32, 4, 48, 1024, 128
    return {
        "q": _w((lambda *s: torch.randn(*s, dtype=torch.bfloat16) * 0.8)(B, Hq, Sq, D)),
        "k": _w((lambda *s: torch.randn(*s, dtype=torch.bfloat16) * 0.8)(B, Hkv, Sk, D)),
        "v": _w((lambda *s: torch.randn(*s, dtype=torch.bfloat16) * 0.05)(B, Hkv, Sk, D)),
    }

def reference(q, k, v):
    B, Hq, Sq, D = q.shape
    Hkv = k.shape[1]
    rep = Hq // Hkv
    k = (lambda x, n, axis: torch.repeat_interleave(x, n, dim=axis))(k, rep, axis=1)
    v = (lambda x, n, axis: torch.repeat_interleave(x, n, dim=axis))(v, rep, axis=1)
    scale = D ** -0.5
    scores = torch.einsum("bhqd,bhkd->bhqk", q, k) * scale
    p = _softmax(scores, axis=-1)
    return torch.einsum("bhqk,bhkd->bhqd", p, v)
```

```asm
; @launch grid=(256,1,1) block=(256,1,1) lds=163840
.amdgcn_target "amdgcn-amd-amdhsa--gfx950"
.text
.globl standalone__gqa_softmax__near_ridge_kernel
.p2align 12
.p2align 8
.type standalone__gqa_softmax__near_ridge_kernel,@function
standalone__gqa_softmax__near_ridge_kernel:
    s_load_dwordx8 s[4:11], s[0:1], 0
    s_cmp_ge_u32 s2, 256
    s_cbranch_scc1 L_end
    s_getpc_b64 s[100:101]
L_pc:
    s_lshr_b32 s38, s2, 3
    s_lshl_b32 s38, s38, 10
    s_min_u32 s38, s38, L_all_end - L_pc - 1024
    v_lshl_add_u32 v15, v0, 2, s38
    global_load_dword v15, v15, s[100:101]
    v_lshrrev_b32 v1, 6, v0
    v_and_b32 v2, 15, v0
    v_readfirstlane_b32 s32, v1
    v_bfe_u32 v3, v0, 4, 2
    v_lshlrev_b32 v6, 15, v1
    v_lshl_add_u32 v6, v3, 8, v6
    v_xor_b32_e64 v7, v2, v3
    v_lshl_add_u32 v244, v7, 4, v6
    v_xor_b32_e64 v245, 64, v244
    v_xor_b32 v246, 128, v244
    v_xor_b32 v247, 192, v244
    s_and_b32 s36, s2, 7
    s_lshr_b32 s35, s2, 5
    s_lshl3_add_u32 s36, s36, s35
    s_lshl_b32 s37, s36, 18
    s_lshr_b32 s34, s32, 1
    s_and_b32 s39, s32, 1
    s_mul_i32 s57, s34, 81920
    s_lshl_b32 s33, s39, 13
    s_add_u32 s33, s33, s57
    s_mov_b32 m0, s33
    s_bfe_u32 s35, s2, 0x20003
    s_lshl2_add_u32 s36, s36, s35
    s_mul_i32 s36, s36, 24576
    s_movk_i32 s18, 24576
    s_mov_b32 s19, 0x20000
    s_movk_i32 s93, 4096
    s_movk_i32 s94, 8192
    s_movk_i32 s95, 12288
    s_movk_i32 s96, 16384
    s_movk_i32 s97, 20480
    v_lshlrev_b32 v111, 4, v0
    s_mov_b32 s48, s33
    s_add_u32 s49, s33, 4096
    s_add_u32 s50, s33, 16384
    v_and_b32 v0, 63, v0
    v_lshlrev_b32 v8, 2, v3
    v_xor_b32_e64 v8, v2, v8
    v_lshl_add_u32 v248, v8, 4, v6
    v_xor_b32 v249, 32, v248
    s_waitcnt lgkmcnt(0)
    s_add_u32 s40, s6, s37
    s_addc_u32 s41, s7, 0
    s_add_u32 s42, s40, 131072
    s_addc_u32 s43, s41, 0
    global_load_lds_dwordx4 v244, s[40:41] nt
    global_load_lds_dwordx4 v245, s[40:41] offset:1024 nt
    global_load_lds_dwordx4 v246, s[40:41] offset:2048 nt
    global_load_lds_dwordx4 v247, s[40:41] offset:3072 nt
    s_add_u32 s40, s40, s93
    s_addc_u32 s41, s41, 0
    s_add_u32 s16, s4, s36
    s_addc_u32 s17, s5, 0
    buffer_load_dwordx4 v[136:139], v111, s[16:19], 0 offen nt
    buffer_load_dwordx4 v[140:143], v111, s[16:19], s95 offen nt
    s_mov_b32 m0, s49
    s_nop 0
    global_load_lds_dwordx4 v244, s[42:43] nt
    global_load_lds_dwordx4 v245, s[42:43] offset:1024 nt
    global_load_lds_dwordx4 v246, s[42:43] offset:2048 nt
    global_load_lds_dwordx4 v247, s[42:43] offset:3072 nt
    s_add_u32 s42, s42, s93
    s_addc_u32 s43, s43, 0
    s_add_u32 s44, s8, s37
    s_addc_u32 s45, s9, 0
    s_add_u32 s46, s44, 131072
    s_addc_u32 s47, s45, 0
    s_mov_b32 m0, s50
    s_nop 0
    global_load_lds_dwordx4 v248, s[44:45] nt
    s_add_u32 s51, s33, 20480
    s_add_u32 s52, s33, 32768
    s_add_u32 s53, s33, 36864
    s_add_u32 s54, s33, 49152
    s_add_u32 s55, s33, 53248
    s_mov_b32 s98, 0x3e0293ee
    s_mov_b32 s99, s98
    s_mov_b32 s3, 0xffff0000
    s_add_u32 s35, s33, 65536
    s_lshl_b32 s38, s32, 6
    v_lshl_add_u32 v13, v3, 8, s35
    v_lshl_add_u32 v13, v7, 4, v13
    v_xor_b32 v110, s38, v13
    v_lshlrev_b32 v9, 8, v2
    v_lshl_add_u32 v9, v7, 4, v9
    v_add_u32 v232, s57, v9
    v_lshrrev_b32 v10, 2, v2
    v_lshrrev_b32 v11, 3, v2
    s_movk_i32 s38, 7168
    v_mad_u32_u24 v9, v10, s38, v9
    s_lshl_b32 s38, s39, 10
    s_add_u32 s38, s38, 65536
    v_lshl_add_u32 v9, v11, 16, v9
    v_add_u32 v250, s38, v9
    v_xor_b32 v251, 64, v250
    v_xor_b32 v233, 64, v232
    v_xor_b32 v252, 128, v250
    v_xor_b32 v234, 128, v232
    v_xor_b32 v253, 192, v250
    v_xor_b32 v235, 192, v232
    s_mov_b64 exec, 0
    s_cmp_eq_u32 s32, 1
    s_cbranch_scc1 L_hook1
    s_cmp_eq_u32 s32, 2
    s_cbranch_scc1 L_hook2
    s_cmp_eq_u32 s32, 3
    s_cbranch_scc1 L_hook3
    s_branch L_hook4
L_warm_ret:
    s_mov_b64 exec, -1
    s_mov_b32 s56, 0x46800000
    s_add_u32 s28, s10, s36
    s_addc_u32 s29, s11, 0
    s_mov_b64 s[30:31], s[18:19]
    v_lshrrev_b32_e64 v11, 2, v0
    v_lshl_add_u32 v11, v11, 8, s57
    s_and_b32 s38, s32, 2
    v_xor_b32 v10, s38, v10
    v_lshl_add_u32 v11, v10, 6, v11
    v_and_b32_e64 v12, 1, v3
    v_lshl_add_u32 v11, v12, 5, v11
    v_and_b32_e64 v13, 3, v0
    v_lshl_add_u32 v236, v13, 3, v11
    v_xor_b32 v237, 32, v236
    v_xor_b32 v238, 64, v236
    v_xor_b32 v239, 96, v236
    v_xor_b32 v240, 128, v236
    v_xor_b32 v241, 160, v236
    v_xor_b32 v242, 192, v236
    v_xor_b32 v243, 224, v236
    v_lshrrev_b32_e64 v11, 1, v3
    v_lshl_add_u32 v11, v12, 1, v11
    v_and_b32 v12, 7, v0
    v_xor_b32 v11, v11, v12
    v_lshl_add_u32 v13, v2, 7, s35
    v_lshl_add_u32 v76, v11, 4, v13
    v_xor_b32_e64 v77, 64, v76
    v_lshl_add_u32 v108, v0, 4, s35
    s_mul_i32 s38, s39, 96
    s_add_u32 s38, s38, s34
    s_lshl_b32 s38, s38, 7
    v_lshrrev_b32 v13, 3, v0
    v_xor_b32 v12, v12, v13
    v_lshl_add_u32 v13, v13, 8, s38
    v_lshl_add_u32 v1, v12, 4, v13
    s_lshl_b32 s38, s39, 15
    s_add_u32 s4, s38, s57
    s_sub_u32 s38, s38, s57
    s_add_u32 s38, s38, 81920
    v_lshl_add_u32 v104, v0, 4, s4
    v_lshl_add_u32 v105, v0, 3, s4
    v_lshl_add_u32 v106, v0, 4, s38
    v_lshl_add_u32 v107, v0, 3, s38
    v_mov_b32 v96, 0x3f803f80
    v_mov_b32 v97, 0x3f803f80
    v_mov_b32 v98, 0x3f803f80
    v_mov_b32 v99, 0x3f803f80
    buffer_load_dwordx4 v[144:147], v111, s[16:19], s93 offen nt
    buffer_load_dwordx4 v[148:151], v111, s[16:19], s96 offen nt
    global_load_lds_dwordx4 v249, s[44:45] offset:1024 nt
    s_waitcnt vmcnt(9)
    v_lshlrev_b32 v160, 16, v136
    v_and_b32 v161, s3, v136
    v_lshlrev_b32 v162, 16, v137
    v_and_b32 v163, s3, v137
    v_lshlrev_b32 v164, 16, v138
    v_and_b32 v165, s3, v138
    v_lshlrev_b32 v166, 16, v139
    v_and_b32 v167, s3, v139
    v_pk_mul_f32 v[160:161], v[160:161], s[98:99]
    v_pk_mul_f32 v[162:163], v[162:163], s[98:99]
    v_pk_mul_f32 v[164:165], v[164:165], s[98:99]
    v_pk_mul_f32 v[166:167], v[166:167], s[98:99]
    v_cvt_pk_bf16_f32 v136, v160, v161
    v_cvt_pk_bf16_f32 v137, v162, v163
    v_cvt_pk_bf16_f32 v138, v164, v165
    v_cvt_pk_bf16_f32 v139, v166, v167
    ds_write_b128 v110, v[136:139]
    global_load_lds_dwordx4 v248, s[44:45] offset:2048 nt
    s_waitcnt vmcnt(9)
    v_lshlrev_b32 v160, 16, v140
    v_and_b32 v161, s3, v140
    v_lshlrev_b32 v162, 16, v141
    v_and_b32 v163, s3, v141
    v_lshlrev_b32 v164, 16, v142
    v_and_b32 v165, s3, v142
    v_lshlrev_b32 v166, 16, v143
    v_and_b32_e64 v167, s3, v143
    v_pk_mul_f32 v[160:161], v[160:161], s[98:99]
    v_pk_mul_f32 v[162:163], v[162:163], s[98:99]
    v_pk_mul_f32 v[164:165], v[164:165], s[98:99]
    v_pk_mul_f32 v[166:167], v[166:167], s[98:99]
    v_cvt_pk_bf16_f32 v140, v160, v161
    v_cvt_pk_bf16_f32 v141, v162, v163
    v_cvt_pk_bf16_f32 v142, v164, v165
    v_cvt_pk_bf16_f32 v143, v166, v167
    ds_write_b128 v110, v[140:143] offset:1024
    global_load_lds_dwordx4 v249, s[44:45] offset:3072 nt
    buffer_load_dwordx4 v[152:155], v111, s[16:19], s94 offen nt
    buffer_load_dwordx4 v[156:159], v111, s[16:19], s97 offen nt
    s_mov_b32 m0, s51
    s_nop 0
    global_load_lds_dwordx4 v248, s[46:47] nt
    s_waitcnt vmcnt(9)
    s_waitcnt lgkmcnt(0)
    s_barrier
    ds_read_b128 a[48:51], v250
    ds_read_b128 a[52:55], v251
    ds_read_b128 a[56:59], v252
    ds_read_b128 a[60:63], v253
    ds_read_b128 a[96:99], v232
    ds_read_b128 a[100:103], v233
    ds_read_b128 a[104:107], v234
    ds_read_b128 a[108:111], v235
    ds_read_b128 a[112:115], v232 offset:4096
    ds_read_b128 a[116:119], v233 offset:4096
L_slot0:
    s_waitcnt lgkmcnt(5)
    v_mfma_f32_16x16x32_bf16 v[16:19], a[96:99], a[48:51], 0
    s_waitcnt lgkmcnt(4)
    ds_read_b128 a[120:123], v234 offset:4096
    ds_read_b128 a[124:127], v235 offset:4096
    v_mfma_f32_16x16x32_bf16 v[16:19], a[100:103], a[52:55], v[16:19]
    s_waitcnt lgkmcnt(5)
    ds_read_b128 a[128:131], v232 offset:8192
    ds_read_b128 a[132:135], v233 offset:8192
    v_mfma_f32_16x16x32_bf16 v[16:19], a[104:107], a[56:59], v[16:19]
    s_waitcnt lgkmcnt(6)
    ds_read_b128 a[136:139], v234 offset:8192
    ds_read_b128 a[140:143], v235 offset:8192
    global_load_lds_dwordx4 v249, s[46:47] offset:1024 nt
    global_load_lds_dwordx4 v248, s[46:47] offset:2048 nt
    s_waitcnt vmcnt(9)
    v_lshlrev_b32_e64 v160, 16, v144
    v_mfma_f32_16x16x32_bf16 v[16:19], a[108:111], a[60:63], v[16:19]
    s_waitcnt lgkmcnt(7)
    ds_read_b128 a[144:147], v232 offset:12288
    ds_read_b128 a[148:151], v233 offset:12288
    v_and_b32 v161, s3, v144
    v_lshlrev_b32_e64 v162, 16, v145
    v_mfma_f32_16x16x32_bf16 v[20:23], a[112:115], a[48:51], 0
    s_waitcnt lgkmcnt(8)
    ds_read_b128 a[152:155], v234 offset:12288
    ds_read_b128 a[156:159], v235 offset:12288
    v_and_b32 v163, s3, v145
    v_lshlrev_b32_e64 v164, 16, v146
    v_mfma_f32_16x16x32_bf16 v[20:23], a[116:119], a[52:55], v[20:23]
    s_waitcnt lgkmcnt(9)
    global_load_lds_dwordx4 v249, s[46:47] offset:3072 nt
    v_and_b32 v165, s3, v146
    v_lshlrev_b32 v166, 16, v147
    v_and_b32 v167, s3, v147
    v_mfma_f32_16x16x32_bf16 v[20:23], a[120:123], a[56:59], v[20:23]
    s_waitcnt lgkmcnt(8)
    s_mov_b32 m0, s52
    s_nop 0
    global_load_lds_dwordx4 v244, s[40:41] nt
    v_mul_f32 v160, s98, v160
    v_mul_f32 v161, s98, v161
    v_mul_f32 v162, s98, v162
    v_mfma_f32_16x16x32_bf16 v[20:23], a[124:127], a[60:63], v[20:23]
    s_waitcnt lgkmcnt(7)
    v_mul_f32 v163, s98, v163
    v_mul_f32 v164, s98, v164
    v_mul_f32 v165, s98, v165
    v_mul_f32_e64 v166, s98, v166
    v_mfma_f32_16x16x32_bf16 v[24:27], a[128:131], a[48:51], 0
    s_waitcnt lgkmcnt(6)
    v_mul_f32 v167, s98, v167
    v_cvt_pk_bf16_f32 v144, v160, v161
    v_cvt_pk_bf16_f32 v145, v162, v163
    v_cvt_pk_bf16_f32 v146, v164, v165
    v_mfma_f32_16x16x32_bf16 v[24:27], a[132:135], a[52:55], v[24:27]
    s_waitcnt lgkmcnt(5)
    v_cvt_pk_bf16_f32 v147, v166, v167
    ds_write_b128 v110, v[144:147] offset:2048
    s_waitcnt vmcnt(10)
    v_mfma_f32_16x16x32_bf16 v[24:27], a[136:139], a[56:59], v[24:27]
    s_waitcnt lgkmcnt(5)
    v_lshlrev_b32 v160, 16, v148
    v_and_b32 v161, s3, v148
    v_lshlrev_b32 v162, 16, v149
    v_and_b32_e64 v163, s3, v149
    v_mfma_f32_16x16x32_bf16 v[24:27], a[140:143], a[60:63], v[24:27]
    s_waitcnt lgkmcnt(3)
    global_load_lds_dwordx4 v245, s[40:41] offset:1024 nt
    v_lshlrev_b32 v164, 16, v150
    v_and_b32 v165, s3, v150
    v_lshlrev_b32 v166, 16, v151
    v_mfma_f32_16x16x32_bf16 v[28:31], a[144:147], a[48:51], 0
    s_add_u32 s44, s44, s93
    v_and_b32 v167, s3, v151
    v_mul_f32 v160, s98, v160
    v_mul_f32 v161, s98, v161
    v_mul_f32_e64 v162, s98, v162
    v_mfma_f32_16x16x32_bf16 v[28:31], a[148:151], a[52:55], v[28:31]
    s_waitcnt lgkmcnt(1)
    v_mul_f32 v163, s98, v163
    v_mul_f32 v164, s98, v164
    v_mul_f32 v165, s98, v165
    v_mul_f32_e64 v166, s98, v166
    v_mfma_f32_16x16x32_bf16 v[28:31], a[152:155], a[56:59], v[28:31]
    s_addc_u32 s45, s45, 0
    v_mul_f32 v167, s98, v167
    v_cvt_pk_bf16_f32 v148, v160, v161
    v_cvt_pk_bf16_f32 v149, v162, v163
    v_cvt_pk_bf16_f32 v150, v164, v165
    v_mfma_f32_16x16x32_bf16 v[28:31], a[156:159], a[60:63], v[28:31]
    s_add_u32 s46, s46, s93
    v_cvt_pk_bf16_f32 v151, v166, v167
    ds_write_b128 v110, v[148:151] offset:3072
L_slot1:
    s_waitcnt lgkmcnt(0)
    s_barrier
    ds_read_b128 a[64:67], v250 offset:2048
    ds_read_b128 a[68:71], v251 offset:2048
    ds_read_b128 a[72:75], v252 offset:2048
    ds_read_b128 a[76:79], v253 offset:2048
    v_max3_f32 v10, v16, v17, v18
    v_max3_f32 v11, v19, v20, v21
    v_max3_f32 v10, v10, v22, v23
    v_max3_f32 v11, v11, v24, v25
    v_max3_f32 v10, v10, v26, v27
    v_max3_f32 v11, v11, v28, v29
    v_max3_f32 v10, v10, v30, v31
    v_max_f32 v10, v10, v11
    v_mov_b32 v11, v10
    s_nop 1
    v_permlane32_swap_b32 v10, v11
    v_max_f32 v10, v10, v11
    v_mov_b32 v11, v10
    s_nop 1
    v_permlane16_swap_b32 v10, v11
    v_max_f32 v10, v10, v11
    v_sub_f32 v64, 0, v10
    v_sub_f32 v65, 0, v10
    v_sub_f32 v66, 0, v10
    v_sub_f32 v67, 0, v10
    v_add_f32 v16, v16, v64
    v_add_f32 v17, v17, v64
    v_add_f32 v18, v18, v64
    v_add_f32 v19, v19, v64
    v_exp_f32 v16, v16
    v_exp_f32 v17, v17
    s_waitcnt lgkmcnt(0)
    v_mfma_f32_16x16x32_bf16 v[32:35], a[96:99], a[64:67], 0
    global_load_lds_dwordx4 v246, s[40:41] offset:2048 nt
    v_exp_f32 v18, v18
    v_mfma_f32_16x16x32_bf16 v[32:35], a[100:103], a[68:71], v[32:35]
    s_addc_u32 s47, s47, 0
    v_exp_f32 v19, v19
    v_add_f32 v20, v20, v64
    v_add_f32 v21, v21, v64
    v_mfma_f32_16x16x32_bf16 v[32:35], a[104:107], a[72:75], v[32:35]
    v_add_f32 v22, v22, v64
    v_add_f32 v23, v23, v64
    v_exp_f32_e64 v20, v20
    v_mfma_f32_16x16x32_bf16 v[32:35], a[108:111], a[76:79], v[32:35]
    v_exp_f32 v21, v21
    v_exp_f32 v22, v22
    v_mfma_f32_16x16x32_bf16 v[36:39], a[112:115], a[64:67], 0
    v_cvt_pk_bf16_f32 v112, v16, v17
    v_exp_f32 v23, v23
    v_add_f32 v24, v24, v64
    v_mfma_f32_16x16x32_bf16 v[36:39], a[116:119], a[68:71], v[36:39]
    global_load_lds_dwordx4 v247, s[40:41] offset:3072 nt
    v_cvt_pk_bf16_f32 v113, v18, v19
    v_add_f32 v25, v25, v64
    v_add_f32 v26, v26, v64
    v_mfma_f32_16x16x32_bf16 v[36:39], a[120:123], a[72:75], v[36:39]
    s_add_u32 s40, s40, s93
    s_waitcnt vmcnt(9)
    v_lshlrev_b32 v160, 16, v152
    v_and_b32 v161, s3, v152
    v_lshlrev_b32_e64 v162, 16, v153
    v_mfma_f32_16x16x32_bf16 v[36:39], a[124:127], a[76:79], v[36:39]
    s_addc_u32 s41, s41, 0
    v_and_b32 v163, s3, v153
    v_lshlrev_b32 v164, 16, v154
    v_and_b32 v165, s3, v154
    v_lshlrev_b32_e64 v166, 16, v155
    v_mfma_f32_16x16x32_bf16 v[40:43], a[128:131], a[64:67], 0
    v_and_b32 v167, s3, v155
    v_mul_f32 v160, s98, v160
    v_mul_f32 v161, s98, v161
    v_mul_f32 v162, s98, v162
    v_mfma_f32_16x16x32_bf16 v[40:43], a[132:135], a[68:71], v[40:43]
    v_mul_f32 v163, s98, v163
    v_mul_f32 v164, s98, v164
    v_mul_f32 v165, s98, v165
    v_mul_f32 v166, s98, v166
    v_mfma_f32_16x16x32_bf16 v[40:43], a[136:139], a[72:75], v[40:43]
    s_mov_b32 m0, s53
    s_nop 0
    global_load_lds_dwordx4 v244, s[42:43] nt
    v_mul_f32_e64 v167, s98, v167
    v_cvt_pk_bf16_f32 v152, v160, v161
    v_cvt_pk_bf16_f32 v153, v162, v163
    v_mfma_f32_16x16x32_bf16 v[40:43], a[140:143], a[76:79], v[40:43]
    v_cvt_pk_bf16_f32 v154, v164, v165
    v_cvt_pk_bf16_f32 v155, v166, v167
    ds_write_b128 v110, v[152:155] offset:4096
    v_mfma_f32_16x16x32_bf16 v[44:47], a[144:147], a[64:67], 0
    s_waitcnt vmcnt(9)
    v_lshlrev_b32 v160, 16, v156
    v_and_b32 v161, s3, v156
    v_lshlrev_b32 v162, 16, v157
    v_mfma_f32_16x16x32_bf16 v[44:47], a[148:151], a[68:71], v[44:47]
    v_and_b32 v163, s3, v157
    v_lshlrev_b32 v164, 16, v158
    v_and_b32 v165, s3, v158
    v_lshlrev_b32 v166, 16, v159
    v_mfma_f32_16x16x32_bf16 v[44:47], a[152:155], a[72:75], v[44:47]
    v_and_b32 v167, s3, v159
    v_mul_f32 v160, s98, v160
    v_mul_f32 v161, s98, v161
    v_mul_f32 v162, s98, v162
    v_mfma_f32_16x16x32_bf16 v[44:47], a[156:159], a[76:79], v[44:47]
    global_load_lds_dwordx4 v245, s[42:43] offset:1024 nt
    v_mul_f32 v163, s98, v163
    v_mul_f32 v164, s98, v164
    v_mul_f32 v165, s98, v165
L_slot2:
    v_mul_f32 v166, s98, v166
    v_mul_f32_e64 v167, s98, v167
    v_cvt_pk_bf16_f32 v156, v160, v161
    v_cvt_pk_bf16_f32 v157, v162, v163
    v_cvt_pk_bf16_f32 v158, v164, v165
    v_cvt_pk_bf16_f32 v159, v166, v167
    ds_write_b128 v110, v[156:159] offset:5120
    v_add_f32 v27, v27, v64
    v_exp_f32 v24, v24
    v_exp_f32 v25, v25
    v_exp_f32 v26, v26
    v_exp_f32 v27, v27
    v_add_f32 v28, v28, v64
    v_add_f32 v29, v29, v64
    v_add_f32 v30, v30, v64
    v_add_f32 v31, v31, v64
    v_exp_f32 v28, v28
    v_exp_f32 v29, v29
    v_exp_f32 v30, v30
    v_exp_f32_e64 v31, v31
    v_cvt_pk_bf16_f32 v114, v20, v21
    v_cvt_pk_bf16_f32 v115, v22, v23
    v_cvt_pk_bf16_f32 v116, v24, v25
    v_cvt_pk_bf16_f32 v117, v26, v27
    v_cvt_pk_bf16_f32 v118, v28, v29
    v_cvt_pk_bf16_f32 v119, v30, v31
    global_load_lds_dwordx4 v246, s[42:43] offset:2048 nt
    global_load_lds_dwordx4 v247, s[42:43] offset:3072 nt
    s_mov_b32 m0, s54
    s_nop 0
    global_load_lds_dwordx4 v248, s[44:45] nt
    s_waitcnt vmcnt(9)
    s_waitcnt lgkmcnt(0)
    s_barrier
    ds_read_b128 a[80:83], v250 offset:4096
    ds_read_b128 a[84:87], v251 offset:4096
    ds_read_b128 a[88:91], v252 offset:4096
    ds_read_b128 a[92:95], v253 offset:4096
    v_max3_f32 v10, v32, v33, v34
    v_max3_f32 v11, v35, v36, v37
    v_max3_f32 v10, v10, v38, v39
    v_max3_f32 v11, v11, v40, v41
    v_max3_f32 v10, v10, v42, v43
    v_max3_f32 v11, v11, v44, v45
    v_max3_f32 v10, v10, v46, v47
    v_max_f32 v10, v10, v11
    v_mov_b32 v11, v10
    s_nop 1
    v_permlane32_swap_b32 v10, v11
    v_max_f32 v10, v10, v11
    v_mov_b32 v11, v10
    s_nop 1
    v_permlane16_swap_b32 v10, v11
    v_max_f32 v10, v10, v11
    v_sub_f32 v68, 0, v10
    v_sub_f32 v69, 0, v10
    v_sub_f32 v70, 0, v10
    v_sub_f32 v71, 0, v10
    v_add_f32 v32, v32, v68
    v_add_f32 v33, v33, v68
    v_add_f32 v34, v34, v68
    v_add_f32 v35, v35, v68
    v_exp_f32 v32, v32
    v_exp_f32 v33, v33
    s_waitcnt lgkmcnt(0)
    v_mfma_f32_16x16x32_bf16 v[48:51], a[96:99], a[80:83], 0
    s_add_u32 s42, s42, s93
    v_exp_f32_e64 v34, v34
    v_mfma_f32_16x16x32_bf16 v[48:51], a[100:103], a[84:87], v[48:51]
    ds_read_b64_tr_b16 a[160:161], v240 offset:16384
    ds_read_b64_tr_b16 a[162:163], v240 offset:20480
    v_mfma_f32_16x16x32_bf16 v[48:51], a[104:107], a[88:91], v[48:51]
    s_addc_u32 s43, s43, 0
    v_exp_f32 v35, v35
    v_mfma_f32_16x16x32_bf16 v[48:51], a[108:111], a[92:95], v[48:51]
    ds_read_b64_tr_b16 a[164:165], v240 offset:24576
    ds_read_b64_tr_b16 a[166:167], v240 offset:28672
    v_mfma_f32_16x16x32_bf16 v[52:55], a[112:115], a[80:83], 0
    global_load_lds_dwordx4 v249, s[44:45] offset:1024 nt
    v_add_f32_e64 v36, v36, v68
    v_mfma_f32_16x16x32_bf16 v[52:55], a[116:119], a[84:87], v[52:55]
    ds_read_b64_tr_b16 a[168:169], v241 offset:16384
    ds_read_b64_tr_b16 a[170:171], v241 offset:20480
    v_mfma_f32_16x16x32_bf16 v[52:55], a[120:123], a[88:91], v[52:55]
    v_add_f32 v37, v37, v68
    v_add_f32 v38, v38, v68
    v_mfma_f32_16x16x32_bf16 v[52:55], a[124:127], a[92:95], v[52:55]
    ds_read_b64_tr_b16 a[172:173], v241 offset:24576
    ds_read_b64_tr_b16 a[174:175], v241 offset:28672
    v_mfma_f32_16x16x32_bf16 v[56:59], a[128:131], a[80:83], 0
    v_add_f32_e64 v39, v39, v68
    v_cvt_pk_bf16_f32 v120, v32, v33
    v_mfma_f32_16x16x32_bf16 v[56:59], a[132:135], a[84:87], v[56:59]
    ds_read_b64_tr_b16 a[176:177], v242 offset:16384
    ds_read_b64_tr_b16 a[178:179], v242 offset:20480
    v_mfma_f32_16x16x32_bf16 v[56:59], a[136:139], a[88:91], v[56:59]
    global_load_lds_dwordx4 v248, s[44:45] offset:2048 nt
    v_cvt_pk_bf16_f32 v121, v34, v35
    v_mfma_f32_16x16x32_bf16 v[56:59], a[140:143], a[92:95], v[56:59]
    ds_read_b64_tr_b16 a[180:181], v242 offset:24576
    ds_read_b64_tr_b16 a[182:183], v242 offset:28672
    v_mfma_f32_16x16x32_bf16 v[60:63], a[144:147], a[80:83], 0
    v_exp_f32_e64 v36, v36
    v_mfma_f32_16x16x32_bf16 v[60:63], a[148:151], a[84:87], v[60:63]
    ds_read_b64_tr_b16 a[184:185], v243 offset:16384
    ds_read_b64_tr_b16 a[186:187], v243 offset:20480
    v_mfma_f32_16x16x32_bf16 v[60:63], a[152:155], a[88:91], v[60:63]
    global_load_lds_dwordx4 v249, s[44:45] offset:3072 nt
    v_mfma_f32_16x16x32_bf16 v[60:63], a[156:159], a[92:95], v[60:63]
    ds_read_b64_tr_b16 a[188:189], v243 offset:24576
    ds_read_b64_tr_b16 a[190:191], v243 offset:28672
    v_mfma_f32_16x16x32_bf16 v[88:91], v[96:99], v[112:115], 0
    s_add_u32 s44, s44, s93
    v_exp_f32 v37, v37
    v_mfma_f32_16x16x32_bf16 v[88:91], v[96:99], v[116:119], v[88:91]
    s_waitcnt lgkmcnt(6)
    ds_read_b64_tr_b16 a[192:193], v236 offset:16384
    ds_read_b64_tr_b16 a[194:195], v236 offset:20480
    v_mfma_f32_16x16x32_bf16 a[0:3], a[160:163], v[112:115], 0
    ds_read_b64_tr_b16 a[196:197], v236 offset:24576
    ds_read_b64_tr_b16 a[198:199], v236 offset:28672
    v_mfma_f32_16x16x32_bf16 a[0:3], a[164:167], v[116:119], a[0:3]
    ds_read_b64_tr_b16 a[200:201], v237 offset:16384
    ds_read_b64_tr_b16 a[202:203], v237 offset:20480
    v_mfma_f32_16x16x32_bf16 a[4:7], a[168:171], v[112:115], 0
    ds_read_b64_tr_b16 a[204:205], v237 offset:24576
    ds_read_b64_tr_b16 a[206:207], v237 offset:28672
    v_mfma_f32_16x16x32_bf16 a[4:7], a[172:175], v[116:119], a[4:7]
    ds_read_b64_tr_b16 a[208:209], v238 offset:16384
    ds_read_b64_tr_b16 a[210:211], v238 offset:20480
    v_mfma_f32_16x16x32_bf16 a[8:11], a[176:179], v[112:115], 0
    s_waitcnt lgkmcnt(12)
    ds_read_b64_tr_b16 a[212:213], v238 offset:24576
    ds_read_b64_tr_b16 a[214:215], v238 offset:28672
    v_mfma_f32_16x16x32_bf16 a[8:11], a[180:183], v[116:119], a[8:11]
    s_addc_u32 s45, s45, 0
    v_mov_b32 v100, v88
    v_cvt_pk_bf16_f32 v122, v36, v37
    v_mfma_f32_16x16x32_bf16 a[12:15], a[184:187], v[112:115], 0
    s_waitcnt lgkmcnt(12)
    ds_read_b64_tr_b16 a[216:217], v239 offset:16384
    ds_read_b64_tr_b16 a[218:219], v239 offset:20480
    v_mfma_f32_16x16x32_bf16 a[12:15], a[188:191], v[116:119], a[12:15]
    s_waitcnt lgkmcnt(12)
    ds_read_b64_tr_b16 a[220:221], v239 offset:24576
    ds_read_b64_tr_b16 a[222:223], v239 offset:28672
    v_mfma_f32_16x16x32_bf16 v[184:187], a[192:195], v[112:115], 0
    s_waitcnt lgkmcnt(12)
    s_mov_b32 m0, s55
    s_nop 0
    global_load_lds_dwordx4 v248, s[46:47] nt
    v_mfma_f32_16x16x32_bf16 v[184:187], a[196:199], v[116:119], v[184:187]
    s_waitcnt lgkmcnt(10)
    global_load_lds_dwordx4 v249, s[46:47] offset:1024 nt
    v_mfma_f32_16x16x32_bf16 v[188:191], a[200:203], v[112:115], 0
    s_waitcnt lgkmcnt(8)
    v_exp_f32 v38, v38
    v_mfma_f32_16x16x32_bf16 v[188:191], a[204:207], v[116:119], v[188:191]
    s_waitcnt lgkmcnt(6)
    global_load_lds_dwordx4 v248, s[46:47] offset:2048 nt
    v_mfma_f32_16x16x32_bf16 v[192:195], a[208:211], v[112:115], 0
    s_waitcnt lgkmcnt(4)
    v_exp_f32_e64 v39, v39
    v_mfma_f32_16x16x32_bf16 v[192:195], a[212:215], v[116:119], v[192:195]
    s_waitcnt lgkmcnt(2)
    v_add_f32 v40, v40, v68
    v_add_f32_e64 v41, v41, v68
    v_mfma_f32_16x16x32_bf16 v[196:199], a[216:219], v[112:115], 0
    s_waitcnt lgkmcnt(0)
    v_add_f32 v42, v42, v68
    v_add_f32_e64 v43, v43, v68
    v_mfma_f32_16x16x32_bf16 v[196:199], a[220:223], v[116:119], v[196:199]
    v_exp_f32 v40, v40
L_slot3:
    v_exp_f32 v41, v41
    v_exp_f32 v42, v42
    v_exp_f32 v43, v43
    v_add_f32 v44, v44, v68
    v_add_f32 v45, v45, v68
    v_add_f32 v46, v46, v68
    v_add_f32 v47, v47, v68
    v_exp_f32 v44, v44
    v_exp_f32 v45, v45
    v_exp_f32 v46, v46
    v_exp_f32 v47, v47
    v_cvt_pk_bf16_f32 v123, v38, v39
    v_cvt_pk_bf16_f32 v124, v40, v41
    v_cvt_pk_bf16_f32 v125, v42, v43
    v_cvt_pk_bf16_f32 v126, v44, v45
    v_cvt_pk_bf16_f32 v127, v46, v47
    v_mfma_f32_16x16x32_bf16 v[88:91], v[96:99], v[120:123], 0
    global_load_lds_dwordx4 v249, s[46:47] offset:3072 nt
    v_max3_f32 v10, v48, v49, v50
    v_mfma_f32_16x16x32_bf16 v[88:91], v[96:99], v[124:127], v[88:91]
    s_add_u32 s46, s46, s93
    v_max3_f32 v11, v51, v52, v53
    v_max3_f32 v10, v10, v54, v55
    v_mfma_f32_16x16x32_bf16 a[16:19], a[160:163], v[120:123], 0
    s_addc_u32 s47, s47, 0
    v_max3_f32 v11, v11, v56, v57
    v_max3_f32 v10, v10, v58, v59
    v_mfma_f32_16x16x32_bf16 a[16:19], a[164:167], v[124:127], a[16:19]
    s_mov_b32 m0, s48
    s_nop 0
    global_load_lds_dwordx4 v244, s[40:41] nt
    s_waitcnt vmcnt(9)
    s_barrier
    v_max3_f32 v11, v11, v60, v61
    v_mfma_f32_16x16x32_bf16 a[20:23], a[168:171], v[120:123], 0
    ds_read_b128 a[96:99], v232 offset:32768
    ds_read_b128 a[100:103], v233 offset:32768
    v_mfma_f32_16x16x32_bf16 a[20:23], a[172:175], v[124:127], a[20:23]
    global_load_lds_dwordx4 v245, s[40:41] offset:1024 nt
    v_max3_f32 v10, v10, v62, v63
    v_mfma_f32_16x16x32_bf16 a[24:27], a[176:179], v[120:123], 0
    ds_read_b128 a[104:107], v234 offset:32768
    ds_read_b128 a[108:111], v235 offset:32768
    v_mfma_f32_16x16x32_bf16 a[24:27], a[180:183], v[124:127], a[24:27]
    v_mov_b32 v101, v88
    v_max_f32 v10, v10, v11
    v_mfma_f32_16x16x32_bf16 a[28:31], a[184:187], v[120:123], 0
    ds_read_b128 a[112:115], v232 offset:36864
    ds_read_b128 a[116:119], v233 offset:36864
    v_mfma_f32_16x16x32_bf16 a[28:31], a[188:191], v[124:127], a[28:31]
    v_mov_b32 v11, v10
    s_nop 1
    v_permlane32_swap_b32_e64 v10, v11
    v_mfma_f32_16x16x32_bf16 v[200:203], a[192:195], v[120:123], 0
    ds_read_b128 a[120:123], v234 offset:36864
    ds_read_b128 a[124:127], v235 offset:36864
    v_mfma_f32_16x16x32_bf16 v[200:203], a[196:199], v[124:127], v[200:203]
    global_load_lds_dwordx4 v246, s[40:41] offset:2048 nt
    v_max_f32_e64 v10, v10, v11
    v_mfma_f32_16x16x32_bf16 v[204:207], a[200:203], v[120:123], 0
    ds_read_b128 a[128:131], v232 offset:40960
    ds_read_b128 a[132:135], v233 offset:40960
    v_mfma_f32_16x16x32_bf16 v[204:207], a[204:207], v[124:127], v[204:207]
L_hook1:
    s_cbranch_execz L_warm_ret
    s_nop 0
    s_waitcnt lgkmcnt(8)
    v_mov_b32 v11, v10
    s_nop 1
    v_permlane16_swap_b32 v10, v11
    v_mfma_f32_16x16x32_bf16 v[16:19], a[96:99], a[48:51], v[64:67]
    ds_read_b128 a[136:139], v234 offset:40960
    ds_read_b128 a[140:143], v235 offset:40960
    v_mfma_f32_16x16x32_bf16 v[16:19], a[100:103], a[52:55], v[16:19]
    s_waitcnt lgkmcnt(8)
    global_load_lds_dwordx4 v247, s[40:41] offset:3072 nt
    v_max_f32 v10, v10, v11
    v_mfma_f32_16x16x32_bf16 v[16:19], a[104:107], a[56:59], v[16:19]
    ds_read_b128 a[144:147], v232 offset:45056
    ds_read_b128 a[148:151], v233 offset:45056
    v_mfma_f32_16x16x32_bf16 v[16:19], a[108:111], a[60:63], v[16:19]
    s_waitcnt lgkmcnt(8)
    v_sub_f32 v72, 0, v10
    v_sub_f32_e64 v73, 0, v10
    v_mfma_f32_16x16x32_bf16 v[20:23], a[112:115], a[48:51], v[64:67]
    ds_read_b128 a[152:155], v234 offset:45056
    ds_read_b128 a[156:159], v235 offset:45056
    v_mfma_f32_16x16x32_bf16 v[20:23], a[116:119], a[52:55], v[20:23]
    s_waitcnt lgkmcnt(8)
    v_sub_f32 v74, 0, v10
    v_sub_f32_e64 v75, 0, v10
    v_mfma_f32_16x16x32_bf16 v[20:23], a[120:123], a[56:59], v[20:23]
    s_mov_b32 m0, s49
    s_nop 0
    global_load_lds_dwordx4 v244, s[42:43] nt
    v_add_f32_e64 v48, v48, v72
    v_mfma_f32_16x16x32_bf16 v[20:23], a[124:127], a[60:63], v[20:23]
    s_waitcnt lgkmcnt(6)
    v_add_f32 v49, v49, v72
    v_add_f32_e64 v50, v50, v72
    v_mfma_f32_16x16x32_bf16 v[24:27], a[128:131], a[48:51], v[64:67]
    s_add_u32 s40, s40, s93
    v_add_f32 v51, v51, v72
    v_mfma_f32_16x16x32_bf16 v[24:27], a[132:135], a[52:55], v[24:27]
    s_waitcnt lgkmcnt(4)
    v_exp_f32 v48, v48
    v_mfma_f32_16x16x32_bf16 v[24:27], a[136:139], a[56:59], v[24:27]
    s_addc_u32 s41, s41, 0
    v_exp_f32 v49, v49
    v_mfma_f32_16x16x32_bf16 v[24:27], a[140:143], a[60:63], v[24:27]
    s_waitcnt lgkmcnt(2)
    global_load_lds_dwordx4 v245, s[42:43] offset:1024 nt
    v_cvt_pk_bf16_f32 v128, v48, v49
    v_mfma_f32_16x16x32_bf16 v[28:31], a[144:147], a[48:51], v[64:67]
    v_exp_f32 v50, v50
    v_mfma_f32_16x16x32_bf16 v[28:31], a[148:151], a[52:55], v[28:31]
    s_waitcnt lgkmcnt(0)
    v_exp_f32 v51, v51
    v_mfma_f32_16x16x32_bf16 v[28:31], a[152:155], a[56:59], v[28:31]
    v_add_f32 v52, v52, v72
    v_add_f32 v53, v53, v72
    v_mfma_f32_16x16x32_bf16 v[28:31], a[156:159], a[60:63], v[28:31]
    v_add_f32 v54, v54, v72
    v_add_f32 v55, v55, v72
L_slot4:
    v_mfma_f32_16x16x32_bf16 v[208:211], a[208:211], v[120:123], 0
    global_load_lds_dwordx4 v246, s[42:43] offset:2048 nt
    v_cvt_pk_bf16_f32 v129, v50, v51
    v_mfma_f32_16x16x32_bf16 v[208:211], a[212:215], v[124:127], v[208:211]
    v_exp_f32_e64 v52, v52
    v_mfma_f32_16x16x32_bf16 v[212:215], a[216:219], v[120:123], 0
    v_exp_f32_e64 v53, v53
    v_mfma_f32_16x16x32_bf16 v[212:215], a[220:223], v[124:127], v[212:215]
    v_exp_f32 v54, v54
    v_exp_f32 v55, v55
    v_add_f32 v56, v56, v72
    v_add_f32 v57, v57, v72
    v_add_f32 v58, v58, v72
    v_add_f32 v59, v59, v72
    v_exp_f32 v56, v56
    v_exp_f32 v57, v57
    v_exp_f32 v58, v58
    v_exp_f32 v59, v59
    v_add_f32 v60, v60, v72
    v_add_f32 v61, v61, v72
    v_add_f32 v62, v62, v72
    v_add_f32 v63, v63, v72
    v_exp_f32 v60, v60
    v_exp_f32 v61, v61
    v_exp_f32 v62, v62
    v_exp_f32 v63, v63
    v_cvt_pk_bf16_f32 v130, v52, v53
    v_cvt_pk_bf16_f32 v131, v54, v55
    v_cvt_pk_bf16_f32 v132, v56, v57
    v_cvt_pk_bf16_f32 v133, v58, v59
    v_cvt_pk_bf16_f32 v134, v60, v61
    v_cvt_pk_bf16_f32 v135, v62, v63
    v_mfma_f32_16x16x32_bf16 v[88:91], v[96:99], v[128:131], 0
    v_exp_f32_e64 v152, v16
    v_mfma_f32_16x16x32_bf16 v[88:91], v[96:99], v[132:135], v[88:91]
    global_load_lds_dwordx4 v247, s[42:43] offset:3072 nt
    v_mfma_f32_16x16x32_bf16 a[32:35], a[160:163], v[128:131], 0
    s_add_u32 s42, s42, s93
    v_exp_f32 v153, v17
    v_mfma_f32_16x16x32_bf16 a[32:35], a[164:167], v[132:135], a[32:35]
    s_addc_u32 s43, s43, 0
    v_exp_f32 v154, v18
    v_mfma_f32_16x16x32_bf16 a[36:39], a[168:171], v[128:131], 0
    v_exp_f32_e64 v155, v19
    v_mfma_f32_16x16x32_bf16 a[36:39], a[172:175], v[132:135], a[36:39]
    v_cvt_pk_bf16_f32 v112, v152, v153
    v_mfma_f32_16x16x32_bf16 a[40:43], a[176:179], v[128:131], 0
    v_exp_f32_e64 v156, v20
    v_mfma_f32_16x16x32_bf16 a[40:43], a[180:183], v[132:135], a[40:43]
    s_mov_b32 m0, s50
    v_mov_b32 v102, v88
    v_cvt_pk_bf16_f32 v113, v154, v155
    v_mfma_f32_16x16x32_bf16 a[44:47], a[184:187], v[128:131], 0
    global_load_lds_dwordx4 v248, s[44:45] nt
    v_mfma_f32_16x16x32_bf16 a[44:47], a[188:191], v[132:135], a[44:47]
    v_exp_f32_e64 v157, v21
    v_mfma_f32_16x16x32_bf16 v[32:35], a[96:99], a[64:67], v[68:71]
    v_exp_f32_e64 v158, v22
    v_mfma_f32_16x16x32_bf16 v[32:35], a[100:103], a[68:71], v[32:35]
    v_exp_f32_e64 v159, v23
    v_mfma_f32_16x16x32_bf16 v[32:35], a[104:107], a[72:75], v[32:35]
    v_exp_f32_e64 v160, v24
    v_mfma_f32_16x16x32_bf16 v[32:35], a[108:111], a[76:79], v[32:35]
    s_waitcnt vmcnt(9)
    s_barrier
    v_cvt_pk_bf16_f32 v114, v156, v157
    v_mfma_f32_16x16x32_bf16 v[36:39], a[112:115], a[64:67], v[68:71]
    ds_read_b64_tr_b16 a[160:161], v240 offset:49152
    ds_read_b64_tr_b16 a[162:163], v240 offset:53248
    v_mfma_f32_16x16x32_bf16 v[36:39], a[116:119], a[68:71], v[36:39]
    global_load_lds_dwordx4 v249, s[44:45] offset:1024 nt
    v_cvt_pk_bf16_f32 v115, v158, v159
    v_mfma_f32_16x16x32_bf16 v[36:39], a[120:123], a[72:75], v[36:39]
    ds_read_b64_tr_b16 a[164:165], v240 offset:57344
    ds_read_b64_tr_b16 a[166:167], v240 offset:61440
    v_mfma_f32_16x16x32_bf16 v[36:39], a[124:127], a[76:79], v[36:39]
    v_exp_f32_e64 v161, v25
    v_mfma_f32_16x16x32_bf16 v[40:43], a[128:131], a[64:67], v[68:71]
    ds_read_b64_tr_b16 a[168:169], v241 offset:49152
    ds_read_b64_tr_b16 a[170:171], v241 offset:53248
    v_mfma_f32_16x16x32_bf16 v[40:43], a[132:135], a[68:71], v[40:43]
    v_exp_f32_e64 v162, v26
    v_mfma_f32_16x16x32_bf16 v[40:43], a[136:139], a[72:75], v[40:43]
    ds_read_b64_tr_b16 a[172:173], v241 offset:57344
    ds_read_b64_tr_b16 a[174:175], v241 offset:61440
    v_mfma_f32_16x16x32_bf16 v[40:43], a[140:143], a[76:79], v[40:43]
    global_load_lds_dwordx4 v248, s[44:45] offset:2048 nt
    v_cvt_pk_bf16_f32 v116, v160, v161
    v_mfma_f32_16x16x32_bf16 v[44:47], a[144:147], a[64:67], v[68:71]
    ds_read_b64_tr_b16 a[176:177], v242 offset:49152
    ds_read_b64_tr_b16 a[178:179], v242 offset:53248
    v_mfma_f32_16x16x32_bf16 v[44:47], a[148:151], a[68:71], v[44:47]
    v_exp_f32_e64 v163, v27
    v_mfma_f32_16x16x32_bf16 v[44:47], a[152:155], a[72:75], v[44:47]
    ds_read_b64_tr_b16 a[180:181], v242 offset:57344
    ds_read_b64_tr_b16 a[182:183], v242 offset:61440
    v_mfma_f32_16x16x32_bf16 v[44:47], a[156:159], a[76:79], v[44:47]
    v_exp_f32_e64 v164, v28
    v_mfma_f32_16x16x32_bf16 v[216:219], a[192:195], v[128:131], 0
    ds_read_b64_tr_b16 a[184:185], v243 offset:49152
    ds_read_b64_tr_b16 a[186:187], v243 offset:53248
    v_mfma_f32_16x16x32_bf16 v[216:219], a[196:199], v[132:135], v[216:219]
    global_load_lds_dwordx4 v249, s[44:45] offset:3072 nt
    v_cvt_pk_bf16_f32 v117, v162, v163
    v_mfma_f32_16x16x32_bf16 v[220:223], a[200:203], v[128:131], 0
    ds_read_b64_tr_b16 a[188:189], v243 offset:57344
    ds_read_b64_tr_b16 a[190:191], v243 offset:61440
    v_mfma_f32_16x16x32_bf16 v[220:223], a[204:207], v[132:135], v[220:223]
    s_add_u32 s44, s44, s93
    v_exp_f32 v165, v29
    v_exp_f32 v166, v30
    v_exp_f32 v167, v31
    v_cvt_pk_bf16_f32 v118, v164, v165
    v_cvt_pk_bf16_f32 v119, v166, v167
    v_mfma_f32_16x16x32_bf16 v[88:91], v[96:99], v[112:115], 0
    ds_read_b64_tr_b16 a[192:193], v236 offset:49152
    ds_read_b64_tr_b16 a[194:195], v236 offset:53248
    v_mfma_f32_16x16x32_bf16 v[88:91], v[96:99], v[116:119], v[88:91]
    s_addc_u32 s45, s45, 0
    v_exp_f32 v136, v32
L_slot5:
    v_mfma_f32_16x16x32_bf16 v[224:227], a[208:211], v[128:131], 0
    ds_read_b64_tr_b16 a[196:197], v236 offset:57344
    ds_read_b64_tr_b16 a[198:199], v236 offset:61440
    v_mfma_f32_16x16x32_bf16 v[224:227], a[212:215], v[132:135], v[224:227]
    v_exp_f32_e64 v137, v33
    v_mfma_f32_16x16x32_bf16 v[228:231], a[216:219], v[128:131], 0
    v_cmp_lt_f32_e64 vcc, s56, v88
    v_cvt_pk_bf16_f32 v120, v136, v137
    v_mfma_f32_16x16x32_bf16 v[228:231], a[220:223], v[132:135], v[228:231]
    s_waitcnt lgkmcnt(6)
    s_cbranch_vccnz L_stub3
L_back3:
    v_add_f32_e64 v100, v100, v88
    v_mfma_f32_16x16x32_bf16 a[0:3], a[160:163], v[112:115], a[0:3]
    s_mov_b32 m0, s51
    ds_read_b64_tr_b16 a[200:201], v237 offset:49152
    ds_read_b64_tr_b16 a[202:203], v237 offset:53248
    v_mfma_f32_16x16x32_bf16 a[0:3], a[164:167], v[116:119], a[0:3]
    global_load_lds_dwordx4 v248, s[46:47] nt
    v_mfma_f32_16x16x32_bf16 a[4:7], a[168:171], v[112:115], a[4:7]
    ds_read_b64_tr_b16 a[204:205], v237 offset:57344
    ds_read_b64_tr_b16 a[206:207], v237 offset:61440
    v_mfma_f32_16x16x32_bf16 a[4:7], a[172:175], v[116:119], a[4:7]
    v_exp_f32 v138, v34
    v_mfma_f32_16x16x32_bf16 a[8:11], a[176:179], v[112:115], a[8:11]
    ds_read_b64_tr_b16 a[208:209], v238 offset:49152
    ds_read_b64_tr_b16 a[210:211], v238 offset:53248
    v_mfma_f32_16x16x32_bf16 a[8:11], a[180:183], v[116:119], a[8:11]
    global_load_lds_dwordx4 v249, s[46:47] offset:1024 nt
    v_mfma_f32_16x16x32_bf16 a[12:15], a[184:187], v[112:115], a[12:15]
    s_waitcnt lgkmcnt(10)
    ds_read_b64_tr_b16 a[212:213], v238 offset:57344
    ds_read_b64_tr_b16 a[214:215], v238 offset:61440
    v_mfma_f32_16x16x32_bf16 a[12:15], a[188:191], v[116:119], a[12:15]
    v_exp_f32 v139, v35
    v_mfma_f32_16x16x32_bf16 v[48:51], a[96:99], a[80:83], v[72:75]
    ds_read_b64_tr_b16 a[216:217], v239 offset:49152
    ds_read_b64_tr_b16 a[218:219], v239 offset:53248
    v_mfma_f32_16x16x32_bf16 v[48:51], a[100:103], a[84:87], v[48:51]
    v_exp_f32_e64 v140, v36
    v_mfma_f32_16x16x32_bf16 v[48:51], a[104:107], a[88:91], v[48:51]
    ds_read_b64_tr_b16 a[220:221], v239 offset:57344
    ds_read_b64_tr_b16 a[222:223], v239 offset:61440
    v_mfma_f32_16x16x32_bf16 v[48:51], a[108:111], a[92:95], v[48:51]
    global_load_lds_dwordx4 v248, s[46:47] offset:2048 nt
    v_cvt_pk_bf16_f32 v121, v138, v139
    v_mfma_f32_16x16x32_bf16 v[52:55], a[112:115], a[80:83], v[72:75]
    v_exp_f32_e64 v141, v37
    v_mfma_f32_16x16x32_bf16 v[52:55], a[116:119], a[84:87], v[52:55]
    v_exp_f32_e64 v142, v38
    v_mfma_f32_16x16x32_bf16 v[52:55], a[120:123], a[88:91], v[52:55]
    v_exp_f32_e64 v143, v39
    v_mfma_f32_16x16x32_bf16 v[52:55], a[124:127], a[92:95], v[52:55]
    v_exp_f32_e64 v144, v40
    v_mfma_f32_16x16x32_bf16 v[56:59], a[128:131], a[80:83], v[72:75]
    v_exp_f32_e64 v145, v41
    v_mfma_f32_16x16x32_bf16 v[56:59], a[132:135], a[84:87], v[56:59]
    global_load_lds_dwordx4 v249, s[46:47] offset:3072 nt
    v_cvt_pk_bf16_f32 v122, v140, v141
    v_mfma_f32_16x16x32_bf16 v[56:59], a[136:139], a[88:91], v[56:59]
    s_add_u32 s46, s46, s93
    v_exp_f32 v146, v42
    v_mfma_f32_16x16x32_bf16 v[56:59], a[140:143], a[92:95], v[56:59]
    s_addc_u32 s47, s47, 0
    v_exp_f32 v147, v43
    v_mfma_f32_16x16x32_bf16 v[60:63], a[144:147], a[80:83], v[72:75]
    v_exp_f32_e64 v148, v44
    v_mfma_f32_16x16x32_bf16 v[60:63], a[148:151], a[84:87], v[60:63]
    v_exp_f32_e64 v149, v45
    v_mfma_f32_16x16x32_bf16 v[60:63], a[152:155], a[88:91], v[60:63]
    s_mov_b32 m0, s52
    v_exp_f32 v150, v46
    v_mfma_f32_16x16x32_bf16 v[60:63], a[156:159], a[92:95], v[60:63]
    global_load_lds_dwordx4 v244, s[40:41] nt
    v_cvt_pk_bf16_f32 v123, v142, v143
    v_exp_f32_e64 v151, v47
    v_cvt_pk_bf16_f32 v124, v144, v145
    v_cvt_pk_bf16_f32 v125, v146, v147
    v_cvt_pk_bf16_f32 v126, v148, v149
    v_cvt_pk_bf16_f32 v127, v150, v151
    v_mfma_f32_16x16x32_bf16 v[88:91], v[96:99], v[120:123], 0
    v_exp_f32_e64 v152, v48
    v_mfma_f32_16x16x32_bf16 v[88:91], v[96:99], v[124:127], v[88:91]
    s_waitcnt lgkmcnt(0)
    v_exp_f32 v153, v49
    v_mfma_f32_16x16x32_bf16 v[184:187], a[192:195], v[112:115], v[184:187]
    v_exp_f32_e64 v154, v50
    v_mfma_f32_16x16x32_bf16 v[184:187], a[196:199], v[116:119], v[184:187]
    v_exp_f32_e64 v155, v51
    v_mfma_f32_16x16x32_bf16 v[188:191], a[200:203], v[112:115], v[188:191]
    v_exp_f32_e64 v156, v52
    v_mfma_f32_16x16x32_bf16 v[188:191], a[204:207], v[116:119], v[188:191]
    v_exp_f32_e64 v157, v53
L_slot6:
    v_mfma_f32_16x16x32_bf16 v[192:195], a[208:211], v[112:115], v[192:195]
    v_cmp_lt_f32_e64 vcc, s56, v88
    v_cvt_pk_bf16_f32 v128, v152, v153
    v_mfma_f32_16x16x32_bf16 v[192:195], a[212:215], v[116:119], v[192:195]
    s_cbranch_vccnz L_stub4
L_back4:
    v_add_f32 v101, v101, v88
    v_mfma_f32_16x16x32_bf16 v[196:199], a[216:219], v[112:115], v[196:199]
    s_waitcnt vmcnt(9)
    s_barrier
    v_cvt_pk_bf16_f32 v129, v154, v155
    v_mfma_f32_16x16x32_bf16 v[196:199], a[220:223], v[116:119], v[196:199]
    ds_read_b128 a[96:99], v232
    ds_read_b128 a[100:103], v233
    v_mfma_f32_16x16x32_bf16 a[16:19], a[160:163], v[120:123], a[16:19]
    global_load_lds_dwordx4 v245, s[40:41] offset:1024 nt
    v_cvt_pk_bf16_f32 v130, v156, v157
    v_mfma_f32_16x16x32_bf16 a[16:19], a[164:167], v[124:127], a[16:19]
    ds_read_b128 a[104:107], v234
    ds_read_b128 a[108:111], v235
    v_mfma_f32_16x16x32_bf16 a[20:23], a[168:171], v[120:123], a[20:23]
    global_load_lds_dwordx4 v246, s[40:41] offset:2048 nt
    v_mfma_f32_16x16x32_bf16 a[20:23], a[172:175], v[124:127], a[20:23]
    ds_read_b128 a[112:115], v232 offset:4096
    ds_read_b128 a[116:119], v233 offset:4096
    v_mfma_f32_16x16x32_bf16 a[24:27], a[176:179], v[120:123], a[24:27]
    v_exp_f32_e64 v158, v54
    v_mfma_f32_16x16x32_bf16 a[24:27], a[180:183], v[124:127], a[24:27]
    ds_read_b128 a[120:123], v234 offset:4096
    ds_read_b128 a[124:127], v235 offset:4096
    v_mfma_f32_16x16x32_bf16 a[28:31], a[184:187], v[120:123], a[28:31]
    v_exp_f32_e64 v159, v55
    v_mfma_f32_16x16x32_bf16 a[28:31], a[188:191], v[124:127], a[28:31]
    s_waitcnt lgkmcnt(6)
    ds_read_b128 a[128:131], v232 offset:8192
    ds_read_b128 a[132:135], v233 offset:8192
    v_mfma_f32_16x16x32_bf16 v[16:19], a[96:99], a[48:51], v[64:67]
    global_load_lds_dwordx4 v247, s[40:41] offset:3072 nt
    v_cvt_pk_bf16_f32 v131, v158, v159
    v_mfma_f32_16x16x32_bf16 v[16:19], a[100:103], a[52:55], v[16:19]
    s_waitcnt lgkmcnt(6)
    ds_read_b128 a[136:139], v234 offset:8192
    ds_read_b128 a[140:143], v235 offset:8192
    v_mfma_f32_16x16x32_bf16 v[16:19], a[104:107], a[56:59], v[16:19]
    s_add_u32 s40, s40, s93
    v_exp_f32 v160, v56
    v_mfma_f32_16x16x32_bf16 v[16:19], a[108:111], a[60:63], v[16:19]
    s_waitcnt lgkmcnt(6)
    ds_read_b128 a[144:147], v232 offset:12288
    ds_read_b128 a[148:151], v233 offset:12288
    v_mfma_f32_16x16x32_bf16 v[20:23], a[112:115], a[48:51], v[64:67]
    s_addc_u32 s41, s41, 0
    v_exp_f32_e64 v161, v57
    v_mfma_f32_16x16x32_bf16 v[20:23], a[116:119], a[52:55], v[20:23]
    s_waitcnt lgkmcnt(6)
    ds_read_b128 a[152:155], v234 offset:12288
    ds_read_b128 a[156:159], v235 offset:12288
    v_mfma_f32_16x16x32_bf16 v[20:23], a[120:123], a[56:59], v[20:23]
    s_mov_b32 m0, s53
    v_exp_f32_e64 v162, v58
    v_mfma_f32_16x16x32_bf16 v[20:23], a[124:127], a[60:63], v[20:23]
    s_waitcnt lgkmcnt(6)
    global_load_lds_dwordx4 v244, s[42:43] nt
    v_cvt_pk_bf16_f32 v132, v160, v161
    v_mfma_f32_16x16x32_bf16 v[24:27], a[128:131], a[48:51], v[64:67]
    v_exp_f32 v163, v59
    v_mfma_f32_16x16x32_bf16 v[24:27], a[132:135], a[52:55], v[24:27]
    s_waitcnt lgkmcnt(4)
    v_exp_f32 v164, v60
    v_mfma_f32_16x16x32_bf16 v[24:27], a[136:139], a[56:59], v[24:27]
    v_exp_f32_e64 v165, v61
    v_mfma_f32_16x16x32_bf16 v[24:27], a[140:143], a[60:63], v[24:27]
    s_waitcnt lgkmcnt(2)
    v_exp_f32 v166, v62
    v_mfma_f32_16x16x32_bf16 v[28:31], a[144:147], a[48:51], v[64:67]
    v_exp_f32_e64 v167, v63
    v_mfma_f32_16x16x32_bf16 v[28:31], a[148:151], a[52:55], v[28:31]
    s_waitcnt lgkmcnt(0)
    global_load_lds_dwordx4 v245, s[42:43] offset:1024 nt
    v_cvt_pk_bf16_f32 v133, v162, v163
    v_mfma_f32_16x16x32_bf16 v[28:31], a[152:155], a[56:59], v[28:31]
    v_cvt_pk_bf16_f32 v134, v164, v165
    v_cvt_pk_bf16_f32 v135, v166, v167
    v_mfma_f32_16x16x32_bf16 v[28:31], a[156:159], a[60:63], v[28:31]
    v_exp_f32 v136, v16
    v_mfma_f32_16x16x32_bf16 v[88:91], v[96:99], v[128:131], 0
    v_exp_f32_e64 v137, v17
    v_mfma_f32_16x16x32_bf16 v[88:91], v[96:99], v[132:135], v[88:91]
    v_exp_f32_e64 v138, v18
    v_mfma_f32_16x16x32_bf16 v[200:203], a[192:195], v[120:123], v[200:203]
    v_exp_f32_e64 v139, v19
    v_mfma_f32_16x16x32_bf16 v[200:203], a[196:199], v[124:127], v[200:203]
    global_load_lds_dwordx4 v246, s[42:43] offset:2048 nt
    v_cvt_pk_bf16_f32 v112, v136, v137
    v_mfma_f32_16x16x32_bf16 v[204:207], a[200:203], v[120:123], v[204:207]
    v_exp_f32_e64 v140, v20
    v_mfma_f32_16x16x32_bf16 v[204:207], a[204:207], v[124:127], v[204:207]
    v_exp_f32_e64 v141, v21
L_slot7:
    v_mfma_f32_16x16x32_bf16 v[208:211], a[208:211], v[120:123], v[208:211]
    v_cmp_lt_f32_e64 vcc, s56, v88
    v_cvt_pk_bf16_f32 v113, v138, v139
    v_mfma_f32_16x16x32_bf16 v[208:211], a[212:215], v[124:127], v[208:211]
    s_cbranch_vccnz L_stub5
L_back5:
    v_add_f32 v102, v102, v88
    v_mfma_f32_16x16x32_bf16 v[212:215], a[216:219], v[120:123], v[212:215]
    v_exp_f32_e64 v142, v22
    v_mfma_f32_16x16x32_bf16 v[212:215], a[220:223], v[124:127], v[212:215]
    v_exp_f32_e64 v143, v23
    v_mfma_f32_16x16x32_bf16 a[32:35], a[160:163], v[128:131], a[32:35]
    global_load_lds_dwordx4 v247, s[42:43] offset:3072 nt
    v_cvt_pk_bf16_f32 v114, v140, v141
    v_mfma_f32_16x16x32_bf16 a[32:35], a[164:167], v[132:135], a[32:35]
    s_add_u32 s42, s42, s93
    v_exp_f32 v144, v24
    v_mfma_f32_16x16x32_bf16 a[36:39], a[168:171], v[128:131], a[36:39]
    s_addc_u32 s43, s43, 0
    v_exp_f32 v145, v25
    v_mfma_f32_16x16x32_bf16 a[36:39], a[172:175], v[132:135], a[36:39]
    v_exp_f32_e64 v146, v26
    v_mfma_f32_16x16x32_bf16 a[40:43], a[176:179], v[128:131], a[40:43]
    v_exp_f32_e64 v147, v27
    v_mfma_f32_16x16x32_bf16 a[40:43], a[180:183], v[132:135], a[40:43]
    s_mov_b32 m0, s54
    v_exp_f32 v148, v28
    v_mfma_f32_16x16x32_bf16 a[44:47], a[184:187], v[128:131], a[44:47]
    global_load_lds_dwordx4 v248, s[44:45] nt
    v_cvt_pk_bf16_f32 v115, v142, v143
    v_mfma_f32_16x16x32_bf16 a[44:47], a[188:191], v[132:135], a[44:47]
    v_exp_f32_e64 v149, v29
    v_mfma_f32_16x16x32_bf16 v[32:35], a[96:99], a[64:67], v[68:71]
    v_exp_f32_e64 v150, v30
    v_mfma_f32_16x16x32_bf16 v[32:35], a[100:103], a[68:71], v[32:35]
    v_exp_f32_e64 v151, v31
    v_mfma_f32_16x16x32_bf16 v[32:35], a[104:107], a[72:75], v[32:35]
    v_cvt_pk_bf16_f32 v116, v144, v145
    v_cvt_pk_bf16_f32 v117, v146, v147
    v_mfma_f32_16x16x32_bf16 v[32:35], a[108:111], a[76:79], v[32:35]
    s_waitcnt vmcnt(9)
    s_barrier
    v_cvt_pk_bf16_f32 v118, v148, v149
    v_mfma_f32_16x16x32_bf16 v[36:39], a[112:115], a[64:67], v[68:71]
    ds_read_b64_tr_b16 a[160:161], v240 offset:16384
    ds_read_b64_tr_b16 a[162:163], v240 offset:20480
    v_mfma_f32_16x16x32_bf16 v[36:39], a[116:119], a[68:71], v[36:39]
    global_load_lds_dwordx4 v249, s[44:45] offset:1024 nt
    v_cvt_pk_bf16_f32 v119, v150, v151
    v_mfma_f32_16x16x32_bf16 v[36:39], a[120:123], a[72:75], v[36:39]
    ds_read_b64_tr_b16 a[164:165], v240 offset:24576
    ds_read_b64_tr_b16 a[166:167], v240 offset:28672
    v_mfma_f32_16x16x32_bf16 v[36:39], a[124:127], a[76:79], v[36:39]
    v_mfma_f32_16x16x32_bf16 v[40:43], a[128:131], a[64:67], v[68:71]
    ds_read_b64_tr_b16 a[168:169], v241 offset:16384
    ds_read_b64_tr_b16 a[170:171], v241 offset:20480
    v_mfma_f32_16x16x32_bf16 v[40:43], a[132:135], a[68:71], v[40:43]
    v_exp_f32_e64 v152, v32
    v_mfma_f32_16x16x32_bf16 v[40:43], a[136:139], a[72:75], v[40:43]
    ds_read_b64_tr_b16 a[172:173], v241 offset:24576
    ds_read_b64_tr_b16 a[174:175], v241 offset:28672
    v_mfma_f32_16x16x32_bf16 v[40:43], a[140:143], a[76:79], v[40:43]
    global_load_lds_dwordx4 v248, s[44:45] offset:2048 nt
    v_mfma_f32_16x16x32_bf16 v[44:47], a[144:147], a[64:67], v[68:71]
    ds_read_b64_tr_b16 a[176:177], v242 offset:16384
    ds_read_b64_tr_b16 a[178:179], v242 offset:20480
    v_mfma_f32_16x16x32_bf16 v[44:47], a[148:151], a[68:71], v[44:47]
    v_exp_f32_e64 v153, v33
    v_mfma_f32_16x16x32_bf16 v[44:47], a[152:155], a[72:75], v[44:47]
    ds_read_b64_tr_b16 a[180:181], v242 offset:24576
    ds_read_b64_tr_b16 a[182:183], v242 offset:28672
    v_mfma_f32_16x16x32_bf16 v[44:47], a[156:159], a[76:79], v[44:47]
    v_exp_f32_e64 v154, v34
    v_mfma_f32_16x16x32_bf16 v[88:91], v[96:99], v[112:115], 0
    ds_read_b64_tr_b16 a[184:185], v243 offset:16384
    ds_read_b64_tr_b16 a[186:187], v243 offset:20480
    v_mfma_f32_16x16x32_bf16 v[88:91], v[96:99], v[116:119], v[88:91]
    global_load_lds_dwordx4 v249, s[44:45] offset:3072 nt
    v_cvt_pk_bf16_f32 v120, v152, v153
    v_mfma_f32_16x16x32_bf16 v[216:219], a[192:195], v[128:131], v[216:219]
    ds_read_b64_tr_b16 a[188:189], v243 offset:24576
    ds_read_b64_tr_b16 a[190:191], v243 offset:28672
    v_mfma_f32_16x16x32_bf16 v[216:219], a[196:199], v[132:135], v[216:219]
    s_add_u32 s44, s44, s93
    v_exp_f32 v155, v35
    v_mfma_f32_16x16x32_bf16 v[220:223], a[200:203], v[128:131], v[220:223]
    ds_read_b64_tr_b16 a[192:193], v236 offset:16384
    ds_read_b64_tr_b16 a[194:195], v236 offset:20480
    v_mfma_f32_16x16x32_bf16 v[220:223], a[204:207], v[132:135], v[220:223]
    s_addc_u32 s45, s45, 0
    v_exp_f32 v156, v36
L_slot8:
    v_mfma_f32_16x16x32_bf16 v[224:227], a[208:211], v[128:131], v[224:227]
    v_cmp_lt_f32_e64 vcc, s56, v88
    v_cvt_pk_bf16_f32 v121, v154, v155
    v_mfma_f32_16x16x32_bf16 v[224:227], a[212:215], v[132:135], v[224:227]
    s_cbranch_vccnz L_stub6
L_back6:
    v_add_f32 v100, v100, v88
    v_mfma_f32_16x16x32_bf16 v[228:231], a[216:219], v[128:131], v[228:231]
    s_mov_b32 m0, s55
    ds_read_b64_tr_b16 a[196:197], v236 offset:24576
    ds_read_b64_tr_b16 a[198:199], v236 offset:28672
    v_mfma_f32_16x16x32_bf16 v[228:231], a[220:223], v[132:135], v[228:231]
    s_waitcnt lgkmcnt(6)
    global_load_lds_dwordx4 v248, s[46:47] nt
    v_mfma_f32_16x16x32_bf16 a[0:3], a[160:163], v[112:115], a[0:3]
    ds_read_b64_tr_b16 a[200:201], v237 offset:16384
    ds_read_b64_tr_b16 a[202:203], v237 offset:20480
    v_mfma_f32_16x16x32_bf16 a[0:3], a[164:167], v[116:119], a[0:3]
    v_exp_f32_e64 v157, v37
    v_mfma_f32_16x16x32_bf16 a[4:7], a[168:171], v[112:115], a[4:7]
    ds_read_b64_tr_b16 a[204:205], v237 offset:24576
    ds_read_b64_tr_b16 a[206:207], v237 offset:28672
    v_mfma_f32_16x16x32_bf16 a[4:7], a[172:175], v[116:119], a[4:7]
    v_exp_f32_e64 v158, v38
    v_mfma_f32_16x16x32_bf16 a[8:11], a[176:179], v[112:115], a[8:11]
    ds_read_b64_tr_b16 a[208:209], v238 offset:16384
    ds_read_b64_tr_b16 a[210:211], v238 offset:20480
    v_mfma_f32_16x16x32_bf16 a[8:11], a[180:183], v[116:119], a[8:11]
    global_load_lds_dwordx4 v249, s[46:47] offset:1024 nt
    v_cvt_pk_bf16_f32 v122, v156, v157
    v_mfma_f32_16x16x32_bf16 a[12:15], a[184:187], v[112:115], a[12:15]
    s_waitcnt lgkmcnt(10)
    ds_read_b64_tr_b16 a[212:213], v238 offset:24576
    ds_read_b64_tr_b16 a[214:215], v238 offset:28672
    v_mfma_f32_16x16x32_bf16 a[12:15], a[188:191], v[116:119], a[12:15]
    v_exp_f32 v159, v39
    v_mfma_f32_16x16x32_bf16 v[48:51], a[96:99], a[80:83], v[72:75]
    ds_read_b64_tr_b16 a[216:217], v239 offset:16384
    ds_read_b64_tr_b16 a[218:219], v239 offset:20480
    v_mfma_f32_16x16x32_bf16 v[48:51], a[100:103], a[84:87], v[48:51]
    v_exp_f32_e64 v160, v40
    v_mfma_f32_16x16x32_bf16 v[48:51], a[104:107], a[88:91], v[48:51]
    ds_read_b64_tr_b16 a[220:221], v239 offset:24576
    ds_read_b64_tr_b16 a[222:223], v239 offset:28672
    v_mfma_f32_16x16x32_bf16 v[48:51], a[108:111], a[92:95], v[48:51]
    global_load_lds_dwordx4 v248, s[46:47] offset:2048 nt
    v_cvt_pk_bf16_f32 v123, v158, v159
    v_mfma_f32_16x16x32_bf16 v[52:55], a[112:115], a[80:83], v[72:75]
    v_exp_f32_e64 v161, v41
    v_mfma_f32_16x16x32_bf16 v[52:55], a[116:119], a[84:87], v[52:55]
    v_exp_f32_e64 v162, v42
    v_mfma_f32_16x16x32_bf16 v[52:55], a[120:123], a[88:91], v[52:55]
    v_exp_f32_e64 v163, v43
    v_mfma_f32_16x16x32_bf16 v[52:55], a[124:127], a[92:95], v[52:55]
    v_exp_f32_e64 v164, v44
    v_mfma_f32_16x16x32_bf16 v[56:59], a[128:131], a[80:83], v[72:75]
    v_exp_f32_e64 v165, v45
    v_mfma_f32_16x16x32_bf16 v[56:59], a[132:135], a[84:87], v[56:59]
    global_load_lds_dwordx4 v249, s[46:47] offset:3072 nt
    v_cvt_pk_bf16_f32 v124, v160, v161
    v_mfma_f32_16x16x32_bf16 v[56:59], a[136:139], a[88:91], v[56:59]
    s_add_u32 s46, s46, s93
    v_exp_f32 v166, v46
    v_mfma_f32_16x16x32_bf16 v[56:59], a[140:143], a[92:95], v[56:59]
    s_addc_u32 s47, s47, 0
    v_exp_f32 v167, v47
    v_mfma_f32_16x16x32_bf16 v[60:63], a[144:147], a[80:83], v[72:75]
    v_cvt_pk_bf16_f32 v125, v162, v163
    v_cvt_pk_bf16_f32 v126, v164, v165
    v_mfma_f32_16x16x32_bf16 v[60:63], a[148:151], a[84:87], v[60:63]
    v_exp_f32_e64 v136, v48
    v_mfma_f32_16x16x32_bf16 v[60:63], a[152:155], a[88:91], v[60:63]
    s_mov_b32 m0, s48
    v_exp_f32 v137, v49
    v_mfma_f32_16x16x32_bf16 v[60:63], a[156:159], a[92:95], v[60:63]
    global_load_lds_dwordx4 v244, s[40:41] nt
    v_cvt_pk_bf16_f32 v127, v166, v167
    v_mfma_f32_16x16x32_bf16 v[88:91], v[96:99], v[120:123], 0
    v_exp_f32_e64 v138, v50
    v_mfma_f32_16x16x32_bf16 v[88:91], v[96:99], v[124:127], v[88:91]
    s_waitcnt lgkmcnt(0)
    v_exp_f32 v139, v51
    v_mfma_f32_16x16x32_bf16 v[184:187], a[192:195], v[112:115], v[184:187]
    v_exp_f32_e64 v140, v52
    v_mfma_f32_16x16x32_bf16 v[184:187], a[196:199], v[116:119], v[184:187]
    v_exp_f32_e64 v141, v53
    v_mfma_f32_16x16x32_bf16 v[188:191], a[200:203], v[112:115], v[188:191]
    v_exp_f32_e64 v142, v54
    v_mfma_f32_16x16x32_bf16 v[188:191], a[204:207], v[116:119], v[188:191]
    v_exp_f32_e64 v143, v55
L_slot9:
    v_mfma_f32_16x16x32_bf16 v[192:195], a[208:211], v[112:115], v[192:195]
    v_cmp_lt_f32_e64 vcc, s56, v88
    v_cvt_pk_bf16_f32 v128, v136, v137
    v_mfma_f32_16x16x32_bf16 v[192:195], a[212:215], v[116:119], v[192:195]
    s_cbranch_vccnz L_stub7
L_back7:
    v_add_f32 v101, v101, v88
    v_mfma_f32_16x16x32_bf16 v[196:199], a[216:219], v[112:115], v[196:199]
    s_waitcnt vmcnt(9)
    s_barrier
    v_cvt_pk_bf16_f32 v129, v138, v139
    v_mfma_f32_16x16x32_bf16 v[196:199], a[220:223], v[116:119], v[196:199]
    ds_read_b128 a[96:99], v232 offset:32768
    ds_read_b128 a[100:103], v233 offset:32768
    v_mfma_f32_16x16x32_bf16 a[16:19], a[160:163], v[120:123], a[16:19]
    global_load_lds_dwordx4 v245, s[40:41] offset:1024 nt
    v_cvt_pk_bf16_f32 v130, v140, v141
    v_mfma_f32_16x16x32_bf16 a[16:19], a[164:167], v[124:127], a[16:19]
    ds_read_b128 a[104:107], v234 offset:32768
    ds_read_b128 a[108:111], v235 offset:32768
    v_mfma_f32_16x16x32_bf16 a[20:23], a[168:171], v[120:123], a[20:23]
    global_load_lds_dwordx4 v246, s[40:41] offset:2048 nt
    v_cvt_pk_bf16_f32 v131, v142, v143
    v_mfma_f32_16x16x32_bf16 a[20:23], a[172:175], v[124:127], a[20:23]
    ds_read_b128 a[112:115], v232 offset:36864
    ds_read_b128 a[116:119], v233 offset:36864
    v_mfma_f32_16x16x32_bf16 a[24:27], a[176:179], v[120:123], a[24:27]
    v_exp_f32_e64 v144, v56
    v_mfma_f32_16x16x32_bf16 a[24:27], a[180:183], v[124:127], a[24:27]
L_hook2:
    s_cbranch_execz L_warm_ret
    s_nop 0
    ds_read_b128 a[120:123], v234 offset:36864
    ds_read_b128 a[124:127], v235 offset:36864
    v_mfma_f32_16x16x32_bf16 a[28:31], a[184:187], v[120:123], a[28:31]
    v_exp_f32_e64 v145, v57
    v_mfma_f32_16x16x32_bf16 a[28:31], a[188:191], v[124:127], a[28:31]
    s_waitcnt lgkmcnt(6)
    ds_read_b128 a[128:131], v232 offset:40960
    ds_read_b128 a[132:135], v233 offset:40960
    v_mfma_f32_16x16x32_bf16 v[16:19], a[96:99], a[48:51], v[64:67]
    global_load_lds_dwordx4 v247, s[40:41] offset:3072 nt
    v_cvt_pk_bf16_f32 v132, v144, v145
    v_mfma_f32_16x16x32_bf16 v[16:19], a[100:103], a[52:55], v[16:19]
    s_waitcnt lgkmcnt(6)
    ds_read_b128 a[136:139], v234 offset:40960
    ds_read_b128 a[140:143], v235 offset:40960
    v_mfma_f32_16x16x32_bf16 v[16:19], a[104:107], a[56:59], v[16:19]
    s_add_u32 s40, s40, s93
    v_exp_f32 v146, v58
    v_mfma_f32_16x16x32_bf16 v[16:19], a[108:111], a[60:63], v[16:19]
    s_waitcnt lgkmcnt(6)
    ds_read_b128 a[144:147], v232 offset:45056
    ds_read_b128 a[148:151], v233 offset:45056
    v_mfma_f32_16x16x32_bf16 v[20:23], a[112:115], a[48:51], v[64:67]
    s_addc_u32 s41, s41, 0
    v_exp_f32_e64 v147, v59
    v_mfma_f32_16x16x32_bf16 v[20:23], a[116:119], a[52:55], v[20:23]
    s_waitcnt lgkmcnt(6)
    ds_read_b128 a[152:155], v234 offset:45056
    ds_read_b128 a[156:159], v235 offset:45056
    v_mfma_f32_16x16x32_bf16 v[20:23], a[120:123], a[56:59], v[20:23]
    s_mov_b32 m0, s49
    v_exp_f32_e64 v148, v60
    v_mfma_f32_16x16x32_bf16 v[20:23], a[124:127], a[60:63], v[20:23]
    s_waitcnt lgkmcnt(6)
    global_load_lds_dwordx4 v244, s[42:43] nt
    v_cvt_pk_bf16_f32 v133, v146, v147
    v_mfma_f32_16x16x32_bf16 v[24:27], a[128:131], a[48:51], v[64:67]
    v_exp_f32 v149, v61
    v_mfma_f32_16x16x32_bf16 v[24:27], a[132:135], a[52:55], v[24:27]
    s_waitcnt lgkmcnt(4)
    v_exp_f32 v150, v62
    v_mfma_f32_16x16x32_bf16 v[24:27], a[136:139], a[56:59], v[24:27]
    v_exp_f32_e64 v151, v63
    v_mfma_f32_16x16x32_bf16 v[24:27], a[140:143], a[60:63], v[24:27]
    s_waitcnt lgkmcnt(2)
    v_exp_f32 v152, v16
    v_mfma_f32_16x16x32_bf16 v[28:31], a[144:147], a[48:51], v[64:67]
    v_exp_f32_e64 v153, v17
    v_mfma_f32_16x16x32_bf16 v[28:31], a[148:151], a[52:55], v[28:31]
    s_waitcnt lgkmcnt(0)
    global_load_lds_dwordx4 v245, s[42:43] offset:1024 nt
    v_cvt_pk_bf16_f32 v134, v148, v149
    v_mfma_f32_16x16x32_bf16 v[28:31], a[152:155], a[56:59], v[28:31]
    v_exp_f32 v154, v18
    v_mfma_f32_16x16x32_bf16 v[28:31], a[156:159], a[60:63], v[28:31]
    v_exp_f32_e64 v155, v19
    v_cvt_pk_bf16_f32 v135, v150, v151
    v_mfma_f32_16x16x32_bf16 v[88:91], v[96:99], v[128:131], 0
    v_exp_f32_e64 v156, v20
    v_mfma_f32_16x16x32_bf16 v[88:91], v[96:99], v[132:135], v[88:91]
    v_exp_f32_e64 v157, v21
    v_mfma_f32_16x16x32_bf16 v[200:203], a[192:195], v[120:123], v[200:203]
    v_exp_f32_e64 v158, v22
    v_mfma_f32_16x16x32_bf16 v[200:203], a[196:199], v[124:127], v[200:203]
    global_load_lds_dwordx4 v246, s[42:43] offset:2048 nt
    v_cvt_pk_bf16_f32 v112, v152, v153
    v_mfma_f32_16x16x32_bf16 v[204:207], a[200:203], v[120:123], v[204:207]
    v_exp_f32_e64 v159, v23
    v_mfma_f32_16x16x32_bf16 v[204:207], a[204:207], v[124:127], v[204:207]
    v_exp_f32_e64 v160, v24
L_slot10:
    v_mfma_f32_16x16x32_bf16 v[208:211], a[208:211], v[120:123], v[208:211]
    v_cmp_lt_f32_e64 vcc, s56, v88
    v_cvt_pk_bf16_f32 v113, v154, v155
    v_mfma_f32_16x16x32_bf16 v[208:211], a[212:215], v[124:127], v[208:211]
    s_cbranch_vccnz L_stub8
L_back8:
    v_add_f32 v102, v102, v88
    v_mfma_f32_16x16x32_bf16 v[212:215], a[216:219], v[120:123], v[212:215]
    v_exp_f32_e64 v161, v25
    v_mfma_f32_16x16x32_bf16 v[212:215], a[220:223], v[124:127], v[212:215]
    v_exp_f32_e64 v162, v26
    v_mfma_f32_16x16x32_bf16 a[32:35], a[160:163], v[128:131], a[32:35]
    global_load_lds_dwordx4 v247, s[42:43] offset:3072 nt
    v_cvt_pk_bf16_f32 v114, v156, v157
    v_mfma_f32_16x16x32_bf16 a[32:35], a[164:167], v[132:135], a[32:35]
    s_add_u32 s42, s42, s93
    v_exp_f32 v163, v27
    v_mfma_f32_16x16x32_bf16 a[36:39], a[168:171], v[128:131], a[36:39]
    s_addc_u32 s43, s43, 0
    v_exp_f32 v164, v28
    v_mfma_f32_16x16x32_bf16 a[36:39], a[172:175], v[132:135], a[36:39]
    v_exp_f32_e64 v165, v29
    v_mfma_f32_16x16x32_bf16 a[40:43], a[176:179], v[128:131], a[40:43]
    v_exp_f32_e64 v166, v30
    v_mfma_f32_16x16x32_bf16 a[40:43], a[180:183], v[132:135], a[40:43]
    s_mov_b32 m0, s50
    v_exp_f32 v167, v31
    v_mfma_f32_16x16x32_bf16 a[44:47], a[184:187], v[128:131], a[44:47]
    global_load_lds_dwordx4 v248, s[44:45] nt
    v_cvt_pk_bf16_f32 v115, v158, v159
    v_mfma_f32_16x16x32_bf16 a[44:47], a[188:191], v[132:135], a[44:47]
    v_cvt_pk_bf16_f32 v116, v160, v161
    v_cvt_pk_bf16_f32 v117, v162, v163
    v_mfma_f32_16x16x32_bf16 v[32:35], a[96:99], a[64:67], v[68:71]
    v_cvt_pk_bf16_f32 v118, v164, v165
    v_cvt_pk_bf16_f32 v119, v166, v167
    v_mfma_f32_16x16x32_bf16 v[32:35], a[100:103], a[68:71], v[32:35]
    v_mfma_f32_16x16x32_bf16 v[32:35], a[104:107], a[72:75], v[32:35]
    v_mfma_f32_16x16x32_bf16 v[32:35], a[108:111], a[76:79], v[32:35]
    s_waitcnt vmcnt(9)
    s_barrier
    v_mfma_f32_16x16x32_bf16 v[36:39], a[112:115], a[64:67], v[68:71]
    ds_read_b64_tr_b16 a[160:161], v240 offset:49152
    ds_read_b64_tr_b16 a[162:163], v240 offset:53248
    v_mfma_f32_16x16x32_bf16 v[36:39], a[116:119], a[68:71], v[36:39]
    global_load_lds_dwordx4 v249, s[44:45] offset:1024 nt
    v_mfma_f32_16x16x32_bf16 v[36:39], a[120:123], a[72:75], v[36:39]
    ds_read_b64_tr_b16 a[164:165], v240 offset:57344
    ds_read_b64_tr_b16 a[166:167], v240 offset:61440
    v_mfma_f32_16x16x32_bf16 v[36:39], a[124:127], a[76:79], v[36:39]
    v_mfma_f32_16x16x32_bf16 v[40:43], a[128:131], a[64:67], v[68:71]
    ds_read_b64_tr_b16 a[168:169], v241 offset:49152
    ds_read_b64_tr_b16 a[170:171], v241 offset:53248
    v_mfma_f32_16x16x32_bf16 v[40:43], a[132:135], a[68:71], v[40:43]
    v_exp_f32_e64 v136, v32
    v_mfma_f32_16x16x32_bf16 v[40:43], a[136:139], a[72:75], v[40:43]
    ds_read_b64_tr_b16 a[172:173], v241 offset:57344
    ds_read_b64_tr_b16 a[174:175], v241 offset:61440
    v_mfma_f32_16x16x32_bf16 v[40:43], a[140:143], a[76:79], v[40:43]
    global_load_lds_dwordx4 v248, s[44:45] offset:2048 nt
    v_mfma_f32_16x16x32_bf16 v[44:47], a[144:147], a[64:67], v[68:71]
    ds_read_b64_tr_b16 a[176:177], v242 offset:49152
    ds_read_b64_tr_b16 a[178:179], v242 offset:53248
    v_mfma_f32_16x16x32_bf16 v[44:47], a[148:151], a[68:71], v[44:47]
    v_exp_f32_e64 v137, v33
    v_mfma_f32_16x16x32_bf16 v[44:47], a[152:155], a[72:75], v[44:47]
    ds_read_b64_tr_b16 a[180:181], v242 offset:57344
    ds_read_b64_tr_b16 a[182:183], v242 offset:61440
    v_mfma_f32_16x16x32_bf16 v[44:47], a[156:159], a[76:79], v[44:47]
    v_exp_f32_e64 v138, v34
    v_mfma_f32_16x16x32_bf16 v[88:91], v[96:99], v[112:115], 0
    ds_read_b64_tr_b16 a[184:185], v243 offset:49152
    ds_read_b64_tr_b16 a[186:187], v243 offset:53248
    v_mfma_f32_16x16x32_bf16 v[88:91], v[96:99], v[116:119], v[88:91]
    global_load_lds_dwordx4 v249, s[44:45] offset:3072 nt
    v_cvt_pk_bf16_f32 v120, v136, v137
    v_mfma_f32_16x16x32_bf16 v[216:219], a[192:195], v[128:131], v[216:219]
    ds_read_b64_tr_b16 a[188:189], v243 offset:57344
    ds_read_b64_tr_b16 a[190:191], v243 offset:61440
    v_mfma_f32_16x16x32_bf16 v[216:219], a[196:199], v[132:135], v[216:219]
    s_add_u32 s44, s44, s93
    v_exp_f32 v139, v35
    v_mfma_f32_16x16x32_bf16 v[220:223], a[200:203], v[128:131], v[220:223]
    ds_read_b64_tr_b16 a[192:193], v236 offset:49152
    ds_read_b64_tr_b16 a[194:195], v236 offset:53248
    v_mfma_f32_16x16x32_bf16 v[220:223], a[204:207], v[132:135], v[220:223]
    s_addc_u32 s45, s45, 0
    v_exp_f32 v140, v36
L_slot11:
    v_mfma_f32_16x16x32_bf16 v[224:227], a[208:211], v[128:131], v[224:227]
    v_cmp_lt_f32_e64 vcc, s56, v88
    v_cvt_pk_bf16_f32 v121, v138, v139
    v_mfma_f32_16x16x32_bf16 v[224:227], a[212:215], v[132:135], v[224:227]
    s_cbranch_vccnz L_stub9
L_back9:
    v_add_f32 v100, v100, v88
    v_mfma_f32_16x16x32_bf16 v[228:231], a[216:219], v[128:131], v[228:231]
    s_mov_b32 m0, s51
    ds_read_b64_tr_b16 a[196:197], v236 offset:57344
    ds_read_b64_tr_b16 a[198:199], v236 offset:61440
    v_mfma_f32_16x16x32_bf16 v[228:231], a[220:223], v[132:135], v[228:231]
    s_waitcnt lgkmcnt(6)
    global_load_lds_dwordx4 v248, s[46:47] nt
    v_mfma_f32_16x16x32_bf16 a[0:3], a[160:163], v[112:115], a[0:3]
    ds_read_b64_tr_b16 a[200:201], v237 offset:49152
    ds_read_b64_tr_b16 a[202:203], v237 offset:53248
    v_mfma_f32_16x16x32_bf16 a[0:3], a[164:167], v[116:119], a[0:3]
    v_exp_f32_e64 v141, v37
    v_mfma_f32_16x16x32_bf16 a[4:7], a[168:171], v[112:115], a[4:7]
    ds_read_b64_tr_b16 a[204:205], v237 offset:57344
    ds_read_b64_tr_b16 a[206:207], v237 offset:61440
    v_mfma_f32_16x16x32_bf16 a[4:7], a[172:175], v[116:119], a[4:7]
    v_exp_f32_e64 v142, v38
    v_mfma_f32_16x16x32_bf16 a[8:11], a[176:179], v[112:115], a[8:11]
    ds_read_b64_tr_b16 a[208:209], v238 offset:49152
    ds_read_b64_tr_b16 a[210:211], v238 offset:53248
    v_mfma_f32_16x16x32_bf16 a[8:11], a[180:183], v[116:119], a[8:11]
    global_load_lds_dwordx4 v249, s[46:47] offset:1024 nt
    v_cvt_pk_bf16_f32 v122, v140, v141
    v_mfma_f32_16x16x32_bf16 a[12:15], a[184:187], v[112:115], a[12:15]
    s_waitcnt lgkmcnt(10)
    ds_read_b64_tr_b16 a[212:213], v238 offset:57344
    ds_read_b64_tr_b16 a[214:215], v238 offset:61440
    v_mfma_f32_16x16x32_bf16 a[12:15], a[188:191], v[116:119], a[12:15]
    v_exp_f32 v143, v39
    v_mfma_f32_16x16x32_bf16 v[48:51], a[96:99], a[80:83], v[72:75]
    ds_read_b64_tr_b16 a[216:217], v239 offset:49152
    ds_read_b64_tr_b16 a[218:219], v239 offset:53248
    v_mfma_f32_16x16x32_bf16 v[48:51], a[100:103], a[84:87], v[48:51]
    v_exp_f32_e64 v144, v40
    v_mfma_f32_16x16x32_bf16 v[48:51], a[104:107], a[88:91], v[48:51]
    ds_read_b64_tr_b16 a[220:221], v239 offset:57344
    ds_read_b64_tr_b16 a[222:223], v239 offset:61440
    v_mfma_f32_16x16x32_bf16 v[48:51], a[108:111], a[92:95], v[48:51]
    global_load_lds_dwordx4 v248, s[46:47] offset:2048 nt
    v_cvt_pk_bf16_f32 v123, v142, v143
    v_mfma_f32_16x16x32_bf16 v[52:55], a[112:115], a[80:83], v[72:75]
    v_exp_f32_e64 v145, v41
    v_mfma_f32_16x16x32_bf16 v[52:55], a[116:119], a[84:87], v[52:55]
    v_exp_f32_e64 v146, v42
    v_mfma_f32_16x16x32_bf16 v[52:55], a[120:123], a[88:91], v[52:55]
    v_exp_f32_e64 v147, v43
    v_mfma_f32_16x16x32_bf16 v[52:55], a[124:127], a[92:95], v[52:55]
    v_exp_f32_e64 v148, v44
    v_mfma_f32_16x16x32_bf16 v[56:59], a[128:131], a[80:83], v[72:75]
    v_exp_f32_e64 v149, v45
    v_mfma_f32_16x16x32_bf16 v[56:59], a[132:135], a[84:87], v[56:59]
    global_load_lds_dwordx4 v249, s[46:47] offset:3072 nt
    v_cvt_pk_bf16_f32 v124, v144, v145
    v_mfma_f32_16x16x32_bf16 v[56:59], a[136:139], a[88:91], v[56:59]
    s_add_u32 s46, s46, s93
    v_exp_f32 v150, v46
    v_mfma_f32_16x16x32_bf16 v[56:59], a[140:143], a[92:95], v[56:59]
    s_addc_u32 s47, s47, 0
    v_exp_f32 v151, v47
    v_mfma_f32_16x16x32_bf16 v[60:63], a[144:147], a[80:83], v[72:75]
    v_cvt_pk_bf16_f32 v125, v146, v147
    v_cvt_pk_bf16_f32 v126, v148, v149
    v_mfma_f32_16x16x32_bf16 v[60:63], a[148:151], a[84:87], v[60:63]
    v_exp_f32_e64 v152, v48
    v_mfma_f32_16x16x32_bf16 v[60:63], a[152:155], a[88:91], v[60:63]
    s_mov_b32 m0, s52
    v_exp_f32 v153, v49
    v_mfma_f32_16x16x32_bf16 v[60:63], a[156:159], a[92:95], v[60:63]
    global_load_lds_dwordx4 v244, s[40:41] nt
    v_cvt_pk_bf16_f32 v127, v150, v151
    v_mfma_f32_16x16x32_bf16 v[88:91], v[96:99], v[120:123], 0
    v_exp_f32_e64 v154, v50
    v_mfma_f32_16x16x32_bf16 v[88:91], v[96:99], v[124:127], v[88:91]
    s_waitcnt lgkmcnt(0)
    v_exp_f32 v155, v51
    v_mfma_f32_16x16x32_bf16 v[184:187], a[192:195], v[112:115], v[184:187]
    v_exp_f32_e64 v156, v52
    v_mfma_f32_16x16x32_bf16 v[184:187], a[196:199], v[116:119], v[184:187]
    v_exp_f32_e64 v157, v53
    v_mfma_f32_16x16x32_bf16 v[188:191], a[200:203], v[112:115], v[188:191]
    v_exp_f32_e64 v158, v54
    v_mfma_f32_16x16x32_bf16 v[188:191], a[204:207], v[116:119], v[188:191]
    v_exp_f32_e64 v159, v55
L_slot12:
    v_mfma_f32_16x16x32_bf16 v[192:195], a[208:211], v[112:115], v[192:195]
    v_cmp_lt_f32_e64 vcc, s56, v88
    v_cvt_pk_bf16_f32 v128, v152, v153
    v_mfma_f32_16x16x32_bf16 v[192:195], a[212:215], v[116:119], v[192:195]
    s_cbranch_vccnz L_stub10
L_back10:
    v_add_f32 v101, v101, v88
    v_mfma_f32_16x16x32_bf16 v[196:199], a[216:219], v[112:115], v[196:199]
    s_waitcnt vmcnt(9)
    s_barrier
    v_cvt_pk_bf16_f32 v129, v154, v155
    v_mfma_f32_16x16x32_bf16 v[196:199], a[220:223], v[116:119], v[196:199]
    ds_read_b128 a[96:99], v232
    ds_read_b128 a[100:103], v233
    v_mfma_f32_16x16x32_bf16 a[16:19], a[160:163], v[120:123], a[16:19]
    global_load_lds_dwordx4 v245, s[40:41] offset:1024 nt
    v_cvt_pk_bf16_f32 v130, v156, v157
    v_mfma_f32_16x16x32_bf16 a[16:19], a[164:167], v[124:127], a[16:19]
    ds_read_b128 a[104:107], v234
    ds_read_b128 a[108:111], v235
    v_mfma_f32_16x16x32_bf16 a[20:23], a[168:171], v[120:123], a[20:23]
    global_load_lds_dwordx4 v246, s[40:41] offset:2048 nt
    v_cvt_pk_bf16_f32 v131, v158, v159
    v_mfma_f32_16x16x32_bf16 a[20:23], a[172:175], v[124:127], a[20:23]
    ds_read_b128 a[112:115], v232 offset:4096
    ds_read_b128 a[116:119], v233 offset:4096
    v_mfma_f32_16x16x32_bf16 a[24:27], a[176:179], v[120:123], a[24:27]
    v_exp_f32_e64 v160, v56
    v_mfma_f32_16x16x32_bf16 a[24:27], a[180:183], v[124:127], a[24:27]
    ds_read_b128 a[120:123], v234 offset:4096
    ds_read_b128 a[124:127], v235 offset:4096
    v_mfma_f32_16x16x32_bf16 a[28:31], a[184:187], v[120:123], a[28:31]
    v_exp_f32_e64 v161, v57
    v_mfma_f32_16x16x32_bf16 a[28:31], a[188:191], v[124:127], a[28:31]
    s_waitcnt lgkmcnt(6)
    ds_read_b128 a[128:131], v232 offset:8192
    ds_read_b128 a[132:135], v233 offset:8192
    v_mfma_f32_16x16x32_bf16 v[16:19], a[96:99], a[48:51], v[64:67]
    global_load_lds_dwordx4 v247, s[40:41] offset:3072 nt
    v_cvt_pk_bf16_f32 v132, v160, v161
    v_mfma_f32_16x16x32_bf16 v[16:19], a[100:103], a[52:55], v[16:19]
    s_waitcnt lgkmcnt(6)
    ds_read_b128 a[136:139], v234 offset:8192
    ds_read_b128 a[140:143], v235 offset:8192
    v_mfma_f32_16x16x32_bf16 v[16:19], a[104:107], a[56:59], v[16:19]
    s_add_u32 s40, s40, s93
    v_exp_f32 v162, v58
    v_mfma_f32_16x16x32_bf16 v[16:19], a[108:111], a[60:63], v[16:19]
    s_waitcnt lgkmcnt(6)
    ds_read_b128 a[144:147], v232 offset:12288
    ds_read_b128 a[148:151], v233 offset:12288
    v_mfma_f32_16x16x32_bf16 v[20:23], a[112:115], a[48:51], v[64:67]
    s_addc_u32 s41, s41, 0
    v_exp_f32_e64 v163, v59
    v_mfma_f32_16x16x32_bf16 v[20:23], a[116:119], a[52:55], v[20:23]
    s_waitcnt lgkmcnt(6)
    ds_read_b128 a[152:155], v234 offset:12288
    ds_read_b128 a[156:159], v235 offset:12288
    v_mfma_f32_16x16x32_bf16 v[20:23], a[120:123], a[56:59], v[20:23]
    s_mov_b32 m0, s53
    v_exp_f32_e64 v164, v60
    v_mfma_f32_16x16x32_bf16 v[20:23], a[124:127], a[60:63], v[20:23]
    s_waitcnt lgkmcnt(6)
    global_load_lds_dwordx4 v244, s[42:43] nt
    v_cvt_pk_bf16_f32 v133, v162, v163
    v_mfma_f32_16x16x32_bf16 v[24:27], a[128:131], a[48:51], v[64:67]
    v_exp_f32 v165, v61
    v_mfma_f32_16x16x32_bf16 v[24:27], a[132:135], a[52:55], v[24:27]
    s_waitcnt lgkmcnt(4)
    v_exp_f32 v166, v62
    v_mfma_f32_16x16x32_bf16 v[24:27], a[136:139], a[56:59], v[24:27]
    v_exp_f32_e64 v167, v63
    v_mfma_f32_16x16x32_bf16 v[24:27], a[140:143], a[60:63], v[24:27]
    s_waitcnt lgkmcnt(2)
    v_exp_f32 v136, v16
    v_mfma_f32_16x16x32_bf16 v[28:31], a[144:147], a[48:51], v[64:67]
    v_exp_f32_e64 v137, v17
    v_mfma_f32_16x16x32_bf16 v[28:31], a[148:151], a[52:55], v[28:31]
    s_waitcnt lgkmcnt(0)
    global_load_lds_dwordx4 v245, s[42:43] offset:1024 nt
    v_cvt_pk_bf16_f32 v134, v164, v165
    v_mfma_f32_16x16x32_bf16 v[28:31], a[152:155], a[56:59], v[28:31]
    v_exp_f32 v138, v18
    v_mfma_f32_16x16x32_bf16 v[28:31], a[156:159], a[60:63], v[28:31]
    v_exp_f32_e64 v139, v19
    v_cvt_pk_bf16_f32 v135, v166, v167
    v_mfma_f32_16x16x32_bf16 v[88:91], v[96:99], v[128:131], 0
    v_exp_f32_e64 v140, v20
    v_mfma_f32_16x16x32_bf16 v[88:91], v[96:99], v[132:135], v[88:91]
    v_exp_f32_e64 v141, v21
    v_mfma_f32_16x16x32_bf16 v[200:203], a[192:195], v[120:123], v[200:203]
    v_exp_f32_e64 v142, v22
    v_mfma_f32_16x16x32_bf16 v[200:203], a[196:199], v[124:127], v[200:203]
    global_load_lds_dwordx4 v246, s[42:43] offset:2048 nt
    v_cvt_pk_bf16_f32 v112, v136, v137
    v_mfma_f32_16x16x32_bf16 v[204:207], a[200:203], v[120:123], v[204:207]
    v_exp_f32_e64 v143, v23
    v_mfma_f32_16x16x32_bf16 v[204:207], a[204:207], v[124:127], v[204:207]
    v_exp_f32_e64 v144, v24
L_slot13:
    v_mfma_f32_16x16x32_bf16 v[208:211], a[208:211], v[120:123], v[208:211]
    v_cmp_lt_f32_e64 vcc, s56, v88
    v_cvt_pk_bf16_f32 v113, v138, v139
    v_mfma_f32_16x16x32_bf16 v[208:211], a[212:215], v[124:127], v[208:211]
    s_cbranch_vccnz L_stub11
L_back11:
    v_add_f32 v102, v102, v88
    v_mfma_f32_16x16x32_bf16 v[212:215], a[216:219], v[120:123], v[212:215]
    v_exp_f32_e64 v145, v25
    v_mfma_f32_16x16x32_bf16 v[212:215], a[220:223], v[124:127], v[212:215]
    v_exp_f32_e64 v146, v26
    v_mfma_f32_16x16x32_bf16 a[32:35], a[160:163], v[128:131], a[32:35]
    global_load_lds_dwordx4 v247, s[42:43] offset:3072 nt
    v_cvt_pk_bf16_f32 v114, v140, v141
    v_mfma_f32_16x16x32_bf16 a[32:35], a[164:167], v[132:135], a[32:35]
    s_add_u32 s42, s42, s93
    v_exp_f32 v147, v27
    v_mfma_f32_16x16x32_bf16 a[36:39], a[168:171], v[128:131], a[36:39]
    s_addc_u32 s43, s43, 0
    v_exp_f32 v148, v28
    v_mfma_f32_16x16x32_bf16 a[36:39], a[172:175], v[132:135], a[36:39]
    v_exp_f32_e64 v149, v29
    v_mfma_f32_16x16x32_bf16 a[40:43], a[176:179], v[128:131], a[40:43]
    v_exp_f32_e64 v150, v30
    v_mfma_f32_16x16x32_bf16 a[40:43], a[180:183], v[132:135], a[40:43]
    s_mov_b32 m0, s54
    v_exp_f32 v151, v31
    v_mfma_f32_16x16x32_bf16 a[44:47], a[184:187], v[128:131], a[44:47]
    global_load_lds_dwordx4 v248, s[44:45] nt
    v_cvt_pk_bf16_f32 v115, v142, v143
    v_mfma_f32_16x16x32_bf16 a[44:47], a[188:191], v[132:135], a[44:47]
    v_cvt_pk_bf16_f32 v116, v144, v145
    v_cvt_pk_bf16_f32 v117, v146, v147
    v_mfma_f32_16x16x32_bf16 v[32:35], a[96:99], a[64:67], v[68:71]
    v_cvt_pk_bf16_f32 v118, v148, v149
    v_cvt_pk_bf16_f32 v119, v150, v151
    v_mfma_f32_16x16x32_bf16 v[32:35], a[100:103], a[68:71], v[32:35]
    v_mfma_f32_16x16x32_bf16 v[32:35], a[104:107], a[72:75], v[32:35]
    v_mfma_f32_16x16x32_bf16 v[32:35], a[108:111], a[76:79], v[32:35]
    s_waitcnt vmcnt(9)
    s_barrier
    v_mfma_f32_16x16x32_bf16 v[36:39], a[112:115], a[64:67], v[68:71]
    ds_read_b64_tr_b16 a[160:161], v240 offset:16384
    ds_read_b64_tr_b16 a[162:163], v240 offset:20480
    v_mfma_f32_16x16x32_bf16 v[36:39], a[116:119], a[68:71], v[36:39]
    global_load_lds_dwordx4 v249, s[44:45] offset:1024 nt
    v_mfma_f32_16x16x32_bf16 v[36:39], a[120:123], a[72:75], v[36:39]
    ds_read_b64_tr_b16 a[164:165], v240 offset:24576
    ds_read_b64_tr_b16 a[166:167], v240 offset:28672
    v_mfma_f32_16x16x32_bf16 v[36:39], a[124:127], a[76:79], v[36:39]
    v_mfma_f32_16x16x32_bf16 v[40:43], a[128:131], a[64:67], v[68:71]
    ds_read_b64_tr_b16 a[168:169], v241 offset:16384
    ds_read_b64_tr_b16 a[170:171], v241 offset:20480
    v_mfma_f32_16x16x32_bf16 v[40:43], a[132:135], a[68:71], v[40:43]
    v_exp_f32_e64 v152, v32
    v_mfma_f32_16x16x32_bf16 v[40:43], a[136:139], a[72:75], v[40:43]
    ds_read_b64_tr_b16 a[172:173], v241 offset:24576
    ds_read_b64_tr_b16 a[174:175], v241 offset:28672
    v_mfma_f32_16x16x32_bf16 v[40:43], a[140:143], a[76:79], v[40:43]
    global_load_lds_dwordx4 v248, s[44:45] offset:2048 nt
    v_mfma_f32_16x16x32_bf16 v[44:47], a[144:147], a[64:67], v[68:71]
    ds_read_b64_tr_b16 a[176:177], v242 offset:16384
    ds_read_b64_tr_b16 a[178:179], v242 offset:20480
    v_mfma_f32_16x16x32_bf16 v[44:47], a[148:151], a[68:71], v[44:47]
    v_exp_f32_e64 v153, v33
    v_mfma_f32_16x16x32_bf16 v[44:47], a[152:155], a[72:75], v[44:47]
    ds_read_b64_tr_b16 a[180:181], v242 offset:24576
    ds_read_b64_tr_b16 a[182:183], v242 offset:28672
    v_mfma_f32_16x16x32_bf16 v[44:47], a[156:159], a[76:79], v[44:47]
    v_exp_f32_e64 v154, v34
    v_mfma_f32_16x16x32_bf16 v[88:91], v[96:99], v[112:115], 0
    ds_read_b64_tr_b16 a[184:185], v243 offset:16384
    ds_read_b64_tr_b16 a[186:187], v243 offset:20480
    v_mfma_f32_16x16x32_bf16 v[88:91], v[96:99], v[116:119], v[88:91]
    global_load_lds_dwordx4 v249, s[44:45] offset:3072 nt
    v_cvt_pk_bf16_f32 v120, v152, v153
    v_mfma_f32_16x16x32_bf16 v[216:219], a[192:195], v[128:131], v[216:219]
    ds_read_b64_tr_b16 a[188:189], v243 offset:24576
    ds_read_b64_tr_b16 a[190:191], v243 offset:28672
    v_mfma_f32_16x16x32_bf16 v[216:219], a[196:199], v[132:135], v[216:219]
    s_add_u32 s44, s44, s93
    v_exp_f32 v155, v35
    v_mfma_f32_16x16x32_bf16 v[220:223], a[200:203], v[128:131], v[220:223]
    ds_read_b64_tr_b16 a[192:193], v236 offset:16384
    ds_read_b64_tr_b16 a[194:195], v236 offset:20480
    v_mfma_f32_16x16x32_bf16 v[220:223], a[204:207], v[132:135], v[220:223]
    s_addc_u32 s45, s45, 0
    v_exp_f32 v156, v36
L_slot14:
    v_mfma_f32_16x16x32_bf16 v[224:227], a[208:211], v[128:131], v[224:227]
    v_cmp_lt_f32_e64 vcc, s56, v88
    v_cvt_pk_bf16_f32 v121, v154, v155
    v_mfma_f32_16x16x32_bf16 v[224:227], a[212:215], v[132:135], v[224:227]
    s_cbranch_vccnz L_stub12
L_back12:
    v_add_f32 v100, v100, v88
    v_mfma_f32_16x16x32_bf16 v[228:231], a[216:219], v[128:131], v[228:231]
    s_mov_b32 m0, s55
    ds_read_b64_tr_b16 a[196:197], v236 offset:24576
    ds_read_b64_tr_b16 a[198:199], v236 offset:28672
    v_mfma_f32_16x16x32_bf16 v[228:231], a[220:223], v[132:135], v[228:231]
    s_waitcnt lgkmcnt(6)
    global_load_lds_dwordx4 v248, s[46:47] nt
    v_mfma_f32_16x16x32_bf16 a[0:3], a[160:163], v[112:115], a[0:3]
    ds_read_b64_tr_b16 a[200:201], v237 offset:16384
    ds_read_b64_tr_b16 a[202:203], v237 offset:20480
    v_mfma_f32_16x16x32_bf16 a[0:3], a[164:167], v[116:119], a[0:3]
    v_exp_f32_e64 v157, v37
    v_mfma_f32_16x16x32_bf16 a[4:7], a[168:171], v[112:115], a[4:7]
    ds_read_b64_tr_b16 a[204:205], v237 offset:24576
    ds_read_b64_tr_b16 a[206:207], v237 offset:28672
    v_mfma_f32_16x16x32_bf16 a[4:7], a[172:175], v[116:119], a[4:7]
    v_exp_f32_e64 v158, v38
    v_mfma_f32_16x16x32_bf16 a[8:11], a[176:179], v[112:115], a[8:11]
    ds_read_b64_tr_b16 a[208:209], v238 offset:16384
    ds_read_b64_tr_b16 a[210:211], v238 offset:20480
    v_mfma_f32_16x16x32_bf16 a[8:11], a[180:183], v[116:119], a[8:11]
    global_load_lds_dwordx4 v249, s[46:47] offset:1024 nt
    v_cvt_pk_bf16_f32 v122, v156, v157
    v_mfma_f32_16x16x32_bf16 a[12:15], a[184:187], v[112:115], a[12:15]
    s_waitcnt lgkmcnt(10)
    ds_read_b64_tr_b16 a[212:213], v238 offset:24576
    ds_read_b64_tr_b16 a[214:215], v238 offset:28672
    v_mfma_f32_16x16x32_bf16 a[12:15], a[188:191], v[116:119], a[12:15]
    v_exp_f32 v159, v39
    v_mfma_f32_16x16x32_bf16 v[48:51], a[96:99], a[80:83], v[72:75]
    ds_read_b64_tr_b16 a[216:217], v239 offset:16384
    ds_read_b64_tr_b16 a[218:219], v239 offset:20480
    v_mfma_f32_16x16x32_bf16 v[48:51], a[100:103], a[84:87], v[48:51]
    v_exp_f32_e64 v160, v40
    v_mfma_f32_16x16x32_bf16 v[48:51], a[104:107], a[88:91], v[48:51]
    ds_read_b64_tr_b16 a[220:221], v239 offset:24576
    ds_read_b64_tr_b16 a[222:223], v239 offset:28672
    v_mfma_f32_16x16x32_bf16 v[48:51], a[108:111], a[92:95], v[48:51]
    global_load_lds_dwordx4 v248, s[46:47] offset:2048 nt
    v_cvt_pk_bf16_f32 v123, v158, v159
    v_mfma_f32_16x16x32_bf16 v[52:55], a[112:115], a[80:83], v[72:75]
    v_exp_f32_e64 v161, v41
    v_mfma_f32_16x16x32_bf16 v[52:55], a[116:119], a[84:87], v[52:55]
    v_exp_f32_e64 v162, v42
    v_mfma_f32_16x16x32_bf16 v[52:55], a[120:123], a[88:91], v[52:55]
    v_exp_f32_e64 v163, v43
    v_mfma_f32_16x16x32_bf16 v[52:55], a[124:127], a[92:95], v[52:55]
    v_exp_f32_e64 v164, v44
    v_mfma_f32_16x16x32_bf16 v[56:59], a[128:131], a[80:83], v[72:75]
    v_exp_f32_e64 v165, v45
    v_mfma_f32_16x16x32_bf16 v[56:59], a[132:135], a[84:87], v[56:59]
    global_load_lds_dwordx4 v249, s[46:47] offset:3072 nt
    v_cvt_pk_bf16_f32 v124, v160, v161
    v_mfma_f32_16x16x32_bf16 v[56:59], a[136:139], a[88:91], v[56:59]
    s_add_u32 s46, s46, s93
    v_exp_f32 v166, v46
    v_mfma_f32_16x16x32_bf16 v[56:59], a[140:143], a[92:95], v[56:59]
    s_addc_u32 s47, s47, 0
    v_exp_f32 v167, v47
    v_mfma_f32_16x16x32_bf16 v[60:63], a[144:147], a[80:83], v[72:75]
    v_cvt_pk_bf16_f32 v125, v162, v163
    v_cvt_pk_bf16_f32 v126, v164, v165
    v_mfma_f32_16x16x32_bf16 v[60:63], a[148:151], a[84:87], v[60:63]
    v_exp_f32_e64 v136, v48
    v_mfma_f32_16x16x32_bf16 v[60:63], a[152:155], a[88:91], v[60:63]
    s_mov_b32 m0, s48
    v_exp_f32 v137, v49
    v_mfma_f32_16x16x32_bf16 v[60:63], a[156:159], a[92:95], v[60:63]
    global_load_lds_dwordx4 v244, s[40:41] nt
    v_cvt_pk_bf16_f32 v127, v166, v167
    v_mfma_f32_16x16x32_bf16 v[88:91], v[96:99], v[120:123], 0
    v_exp_f32_e64 v138, v50
    v_mfma_f32_16x16x32_bf16 v[88:91], v[96:99], v[124:127], v[88:91]
    s_waitcnt lgkmcnt(0)
    v_exp_f32 v139, v51
    v_mfma_f32_16x16x32_bf16 v[184:187], a[192:195], v[112:115], v[184:187]
    v_exp_f32_e64 v140, v52
    v_mfma_f32_16x16x32_bf16 v[184:187], a[196:199], v[116:119], v[184:187]
    v_exp_f32_e64 v141, v53
    v_mfma_f32_16x16x32_bf16 v[188:191], a[200:203], v[112:115], v[188:191]
    v_exp_f32_e64 v142, v54
    v_mfma_f32_16x16x32_bf16 v[188:191], a[204:207], v[116:119], v[188:191]
    v_exp_f32_e64 v143, v55
L_slot15:
    v_mfma_f32_16x16x32_bf16 v[192:195], a[208:211], v[112:115], v[192:195]
    v_cmp_lt_f32_e64 vcc, s56, v88
    v_cvt_pk_bf16_f32 v128, v136, v137
    v_mfma_f32_16x16x32_bf16 v[192:195], a[212:215], v[116:119], v[192:195]
    s_cbranch_vccnz L_stub13
L_back13:
    v_add_f32 v101, v101, v88
    v_mfma_f32_16x16x32_bf16 v[196:199], a[216:219], v[112:115], v[196:199]
    s_waitcnt vmcnt(9)
    s_barrier
    v_cvt_pk_bf16_f32 v129, v138, v139
    v_mfma_f32_16x16x32_bf16 v[196:199], a[220:223], v[116:119], v[196:199]
    ds_read_b128 a[96:99], v232 offset:32768
    ds_read_b128 a[100:103], v233 offset:32768
    v_mfma_f32_16x16x32_bf16 a[16:19], a[160:163], v[120:123], a[16:19]
    global_load_lds_dwordx4 v245, s[40:41] offset:1024 nt
    v_cvt_pk_bf16_f32 v130, v140, v141
    v_mfma_f32_16x16x32_bf16 a[16:19], a[164:167], v[124:127], a[16:19]
    ds_read_b128 a[104:107], v234 offset:32768
    ds_read_b128 a[108:111], v235 offset:32768
    v_mfma_f32_16x16x32_bf16 a[20:23], a[168:171], v[120:123], a[20:23]
    global_load_lds_dwordx4 v246, s[40:41] offset:2048 nt
    v_cvt_pk_bf16_f32 v131, v142, v143
    v_mfma_f32_16x16x32_bf16 a[20:23], a[172:175], v[124:127], a[20:23]
    ds_read_b128 a[112:115], v232 offset:36864
    ds_read_b128 a[116:119], v233 offset:36864
    v_mfma_f32_16x16x32_bf16 a[24:27], a[176:179], v[120:123], a[24:27]
    v_exp_f32_e64 v144, v56
    v_mfma_f32_16x16x32_bf16 a[24:27], a[180:183], v[124:127], a[24:27]
    ds_read_b128 a[120:123], v234 offset:36864
    ds_read_b128 a[124:127], v235 offset:36864
    v_mfma_f32_16x16x32_bf16 a[28:31], a[184:187], v[120:123], a[28:31]
    v_exp_f32_e64 v145, v57
    v_mfma_f32_16x16x32_bf16 a[28:31], a[188:191], v[124:127], a[28:31]
    s_waitcnt lgkmcnt(6)
    ds_read_b128 a[128:131], v232 offset:40960
    ds_read_b128 a[132:135], v233 offset:40960
    v_mfma_f32_16x16x32_bf16 v[16:19], a[96:99], a[48:51], v[64:67]
    global_load_lds_dwordx4 v247, s[40:41] offset:3072 nt
    v_cvt_pk_bf16_f32 v132, v144, v145
    v_mfma_f32_16x16x32_bf16 v[16:19], a[100:103], a[52:55], v[16:19]
L_hook3:
    s_cbranch_execz L_warm_ret
    s_nop 0
    s_waitcnt lgkmcnt(6)
    ds_read_b128 a[136:139], v234 offset:40960
    ds_read_b128 a[140:143], v235 offset:40960
    v_mfma_f32_16x16x32_bf16 v[16:19], a[104:107], a[56:59], v[16:19]
    s_add_u32 s40, s40, s93
    v_exp_f32 v146, v58
    v_mfma_f32_16x16x32_bf16 v[16:19], a[108:111], a[60:63], v[16:19]
    s_waitcnt lgkmcnt(6)
    ds_read_b128 a[144:147], v232 offset:45056
    ds_read_b128 a[148:151], v233 offset:45056
    v_mfma_f32_16x16x32_bf16 v[20:23], a[112:115], a[48:51], v[64:67]
    s_addc_u32 s41, s41, 0
    v_exp_f32_e64 v147, v59
    v_mfma_f32_16x16x32_bf16 v[20:23], a[116:119], a[52:55], v[20:23]
    s_waitcnt lgkmcnt(6)
    ds_read_b128 a[152:155], v234 offset:45056
    ds_read_b128 a[156:159], v235 offset:45056
    v_mfma_f32_16x16x32_bf16 v[20:23], a[120:123], a[56:59], v[20:23]
    s_mov_b32 m0, s49
    v_exp_f32_e64 v148, v60
    v_mfma_f32_16x16x32_bf16 v[20:23], a[124:127], a[60:63], v[20:23]
    s_waitcnt lgkmcnt(6)
    global_load_lds_dwordx4 v244, s[42:43] nt
    v_cvt_pk_bf16_f32 v133, v146, v147
    v_mfma_f32_16x16x32_bf16 v[24:27], a[128:131], a[48:51], v[64:67]
    v_exp_f32 v149, v61
    v_mfma_f32_16x16x32_bf16 v[24:27], a[132:135], a[52:55], v[24:27]
    s_waitcnt lgkmcnt(4)
    v_exp_f32 v150, v62
    v_mfma_f32_16x16x32_bf16 v[24:27], a[136:139], a[56:59], v[24:27]
    v_exp_f32_e64 v151, v63
    v_mfma_f32_16x16x32_bf16 v[24:27], a[140:143], a[60:63], v[24:27]
    s_waitcnt lgkmcnt(2)
    v_exp_f32 v152, v16
    v_mfma_f32_16x16x32_bf16 v[28:31], a[144:147], a[48:51], v[64:67]
    v_exp_f32_e64 v153, v17
    v_mfma_f32_16x16x32_bf16 v[28:31], a[148:151], a[52:55], v[28:31]
    s_waitcnt lgkmcnt(0)
    global_load_lds_dwordx4 v245, s[42:43] offset:1024 nt
    v_cvt_pk_bf16_f32 v134, v148, v149
    v_mfma_f32_16x16x32_bf16 v[28:31], a[152:155], a[56:59], v[28:31]
    v_exp_f32 v154, v18
    v_mfma_f32_16x16x32_bf16 v[28:31], a[156:159], a[60:63], v[28:31]
    v_exp_f32_e64 v155, v19
    v_cvt_pk_bf16_f32 v135, v150, v151
    v_mfma_f32_16x16x32_bf16 v[88:91], v[96:99], v[128:131], 0
    v_exp_f32_e64 v156, v20
    v_mfma_f32_16x16x32_bf16 v[88:91], v[96:99], v[132:135], v[88:91]
    v_exp_f32_e64 v157, v21
    v_mfma_f32_16x16x32_bf16 v[200:203], a[192:195], v[120:123], v[200:203]
    v_exp_f32_e64 v158, v22
    v_mfma_f32_16x16x32_bf16 v[200:203], a[196:199], v[124:127], v[200:203]
    global_load_lds_dwordx4 v246, s[42:43] offset:2048 nt
    v_cvt_pk_bf16_f32 v112, v152, v153
    v_mfma_f32_16x16x32_bf16 v[204:207], a[200:203], v[120:123], v[204:207]
    v_exp_f32_e64 v159, v23
    v_mfma_f32_16x16x32_bf16 v[204:207], a[204:207], v[124:127], v[204:207]
    v_exp_f32_e64 v160, v24
L_slot16:
    v_mfma_f32_16x16x32_bf16 v[208:211], a[208:211], v[120:123], v[208:211]
    v_cmp_lt_f32_e64 vcc, s56, v88
    v_cvt_pk_bf16_f32 v113, v154, v155
    v_mfma_f32_16x16x32_bf16 v[208:211], a[212:215], v[124:127], v[208:211]
    s_cbranch_vccnz L_stub14
L_back14:
    v_add_f32 v102, v102, v88
    v_mfma_f32_16x16x32_bf16 v[212:215], a[216:219], v[120:123], v[212:215]
    v_exp_f32_e64 v161, v25
    v_mfma_f32_16x16x32_bf16 v[212:215], a[220:223], v[124:127], v[212:215]
    v_exp_f32_e64 v162, v26
    v_mfma_f32_16x16x32_bf16 a[32:35], a[160:163], v[128:131], a[32:35]
    global_load_lds_dwordx4 v247, s[42:43] offset:3072 nt
    v_cvt_pk_bf16_f32 v114, v156, v157
    v_mfma_f32_16x16x32_bf16 a[32:35], a[164:167], v[132:135], a[32:35]
    s_add_u32 s42, s42, s93
    v_exp_f32 v163, v27
    v_mfma_f32_16x16x32_bf16 a[36:39], a[168:171], v[128:131], a[36:39]
    s_addc_u32 s43, s43, 0
    v_exp_f32 v164, v28
    v_mfma_f32_16x16x32_bf16 a[36:39], a[172:175], v[132:135], a[36:39]
    v_exp_f32_e64 v165, v29
    v_mfma_f32_16x16x32_bf16 a[40:43], a[176:179], v[128:131], a[40:43]
    v_exp_f32_e64 v166, v30
    v_mfma_f32_16x16x32_bf16 a[40:43], a[180:183], v[132:135], a[40:43]
    s_mov_b32 m0, s50
    v_exp_f32 v167, v31
    v_mfma_f32_16x16x32_bf16 a[44:47], a[184:187], v[128:131], a[44:47]
    global_load_lds_dwordx4 v248, s[44:45] nt
    v_cvt_pk_bf16_f32 v115, v158, v159
    v_mfma_f32_16x16x32_bf16 a[44:47], a[188:191], v[132:135], a[44:47]
    v_cvt_pk_bf16_f32 v116, v160, v161
    v_cvt_pk_bf16_f32 v117, v162, v163
    v_mfma_f32_16x16x32_bf16 v[32:35], a[96:99], a[64:67], v[68:71]
    v_cvt_pk_bf16_f32 v118, v164, v165
    v_cvt_pk_bf16_f32 v119, v166, v167
    v_mfma_f32_16x16x32_bf16 v[32:35], a[100:103], a[68:71], v[32:35]
    v_mfma_f32_16x16x32_bf16 v[32:35], a[104:107], a[72:75], v[32:35]
    v_mfma_f32_16x16x32_bf16 v[32:35], a[108:111], a[76:79], v[32:35]
    s_waitcnt vmcnt(9)
    s_barrier
    v_mfma_f32_16x16x32_bf16 v[36:39], a[112:115], a[64:67], v[68:71]
    ds_read_b64_tr_b16 a[160:161], v240 offset:49152
    ds_read_b64_tr_b16 a[162:163], v240 offset:53248
    v_mfma_f32_16x16x32_bf16 v[36:39], a[116:119], a[68:71], v[36:39]
    global_load_lds_dwordx4 v249, s[44:45] offset:1024 nt
    v_mfma_f32_16x16x32_bf16 v[36:39], a[120:123], a[72:75], v[36:39]
    ds_read_b64_tr_b16 a[164:165], v240 offset:57344
    ds_read_b64_tr_b16 a[166:167], v240 offset:61440
    v_mfma_f32_16x16x32_bf16 v[36:39], a[124:127], a[76:79], v[36:39]
    v_mfma_f32_16x16x32_bf16 v[40:43], a[128:131], a[64:67], v[68:71]
    ds_read_b64_tr_b16 a[168:169], v241 offset:49152
    ds_read_b64_tr_b16 a[170:171], v241 offset:53248
    v_mfma_f32_16x16x32_bf16 v[40:43], a[132:135], a[68:71], v[40:43]
    v_exp_f32_e64 v136, v32
    v_mfma_f32_16x16x32_bf16 v[40:43], a[136:139], a[72:75], v[40:43]
    ds_read_b64_tr_b16 a[172:173], v241 offset:57344
    ds_read_b64_tr_b16 a[174:175], v241 offset:61440
    v_mfma_f32_16x16x32_bf16 v[40:43], a[140:143], a[76:79], v[40:43]
    global_load_lds_dwordx4 v248, s[44:45] offset:2048 nt
    v_mfma_f32_16x16x32_bf16 v[44:47], a[144:147], a[64:67], v[68:71]
    ds_read_b64_tr_b16 a[176:177], v242 offset:49152
    ds_read_b64_tr_b16 a[178:179], v242 offset:53248
    v_mfma_f32_16x16x32_bf16 v[44:47], a[148:151], a[68:71], v[44:47]
    v_exp_f32_e64 v137, v33
    v_mfma_f32_16x16x32_bf16 v[44:47], a[152:155], a[72:75], v[44:47]
    ds_read_b64_tr_b16 a[180:181], v242 offset:57344
    ds_read_b64_tr_b16 a[182:183], v242 offset:61440
    v_mfma_f32_16x16x32_bf16 v[44:47], a[156:159], a[76:79], v[44:47]
    v_exp_f32_e64 v138, v34
    v_mfma_f32_16x16x32_bf16 v[88:91], v[96:99], v[112:115], 0
    ds_read_b64_tr_b16 a[184:185], v243 offset:49152
    ds_read_b64_tr_b16 a[186:187], v243 offset:53248
    v_mfma_f32_16x16x32_bf16 v[88:91], v[96:99], v[116:119], v[88:91]
    global_load_lds_dwordx4 v249, s[44:45] offset:3072 nt
    v_cvt_pk_bf16_f32 v120, v136, v137
    v_mfma_f32_16x16x32_bf16 v[216:219], a[192:195], v[128:131], v[216:219]
    ds_read_b64_tr_b16 a[188:189], v243 offset:57344
    ds_read_b64_tr_b16 a[190:191], v243 offset:61440
    v_mfma_f32_16x16x32_bf16 v[216:219], a[196:199], v[132:135], v[216:219]
    s_add_u32 s44, s44, s93
    v_exp_f32 v139, v35
    v_mfma_f32_16x16x32_bf16 v[220:223], a[200:203], v[128:131], v[220:223]
    ds_read_b64_tr_b16 a[192:193], v236 offset:49152
    ds_read_b64_tr_b16 a[194:195], v236 offset:53248
    v_mfma_f32_16x16x32_bf16 v[220:223], a[204:207], v[132:135], v[220:223]
    s_addc_u32 s45, s45, 0
    v_exp_f32 v140, v36
L_slot17:
    v_mfma_f32_16x16x32_bf16 v[224:227], a[208:211], v[128:131], v[224:227]
    v_cmp_lt_f32_e64 vcc, s56, v88
    v_cvt_pk_bf16_f32 v121, v138, v139
    v_mfma_f32_16x16x32_bf16 v[224:227], a[212:215], v[132:135], v[224:227]
    s_cbranch_vccnz L_stub15
L_back15:
    v_add_f32 v100, v100, v88
    v_mfma_f32_16x16x32_bf16 v[228:231], a[216:219], v[128:131], v[228:231]
    s_mov_b32 m0, s51
    ds_read_b64_tr_b16 a[196:197], v236 offset:57344
    ds_read_b64_tr_b16 a[198:199], v236 offset:61440
    v_mfma_f32_16x16x32_bf16 v[228:231], a[220:223], v[132:135], v[228:231]
    s_waitcnt lgkmcnt(6)
    global_load_lds_dwordx4 v248, s[46:47] nt
    v_mfma_f32_16x16x32_bf16 a[0:3], a[160:163], v[112:115], a[0:3]
    ds_read_b64_tr_b16 a[200:201], v237 offset:49152
    ds_read_b64_tr_b16 a[202:203], v237 offset:53248
    v_mfma_f32_16x16x32_bf16 a[0:3], a[164:167], v[116:119], a[0:3]
    v_exp_f32_e64 v141, v37
    v_mfma_f32_16x16x32_bf16 a[4:7], a[168:171], v[112:115], a[4:7]
    ds_read_b64_tr_b16 a[204:205], v237 offset:57344
    ds_read_b64_tr_b16 a[206:207], v237 offset:61440
    v_mfma_f32_16x16x32_bf16 a[4:7], a[172:175], v[116:119], a[4:7]
    v_exp_f32_e64 v142, v38
    v_mfma_f32_16x16x32_bf16 a[8:11], a[176:179], v[112:115], a[8:11]
    ds_read_b64_tr_b16 a[208:209], v238 offset:49152
    ds_read_b64_tr_b16 a[210:211], v238 offset:53248
    v_mfma_f32_16x16x32_bf16 a[8:11], a[180:183], v[116:119], a[8:11]
    global_load_lds_dwordx4 v249, s[46:47] offset:1024 nt
    v_cvt_pk_bf16_f32 v122, v140, v141
    v_mfma_f32_16x16x32_bf16 a[12:15], a[184:187], v[112:115], a[12:15]
    s_waitcnt lgkmcnt(10)
    ds_read_b64_tr_b16 a[212:213], v238 offset:57344
    ds_read_b64_tr_b16 a[214:215], v238 offset:61440
    v_mfma_f32_16x16x32_bf16 a[12:15], a[188:191], v[116:119], a[12:15]
    v_exp_f32 v143, v39
    v_mfma_f32_16x16x32_bf16 v[48:51], a[96:99], a[80:83], v[72:75]
    ds_read_b64_tr_b16 a[216:217], v239 offset:49152
    ds_read_b64_tr_b16 a[218:219], v239 offset:53248
    v_mfma_f32_16x16x32_bf16 v[48:51], a[100:103], a[84:87], v[48:51]
    v_exp_f32_e64 v144, v40
    v_mfma_f32_16x16x32_bf16 v[48:51], a[104:107], a[88:91], v[48:51]
    ds_read_b64_tr_b16 a[220:221], v239 offset:57344
    ds_read_b64_tr_b16 a[222:223], v239 offset:61440
    v_mfma_f32_16x16x32_bf16 v[48:51], a[108:111], a[92:95], v[48:51]
    global_load_lds_dwordx4 v248, s[46:47] offset:2048 nt
    v_cvt_pk_bf16_f32 v123, v142, v143
    v_mfma_f32_16x16x32_bf16 v[52:55], a[112:115], a[80:83], v[72:75]
    v_exp_f32_e64 v145, v41
    v_mfma_f32_16x16x32_bf16 v[52:55], a[116:119], a[84:87], v[52:55]
    v_exp_f32_e64 v146, v42
    v_mfma_f32_16x16x32_bf16 v[52:55], a[120:123], a[88:91], v[52:55]
    v_exp_f32_e64 v147, v43
    v_mfma_f32_16x16x32_bf16 v[52:55], a[124:127], a[92:95], v[52:55]
    v_exp_f32_e64 v148, v44
    v_mfma_f32_16x16x32_bf16 v[56:59], a[128:131], a[80:83], v[72:75]
    v_exp_f32_e64 v149, v45
    v_mfma_f32_16x16x32_bf16 v[56:59], a[132:135], a[84:87], v[56:59]
    global_load_lds_dwordx4 v249, s[46:47] offset:3072 nt
    v_cvt_pk_bf16_f32 v124, v144, v145
    v_mfma_f32_16x16x32_bf16 v[56:59], a[136:139], a[88:91], v[56:59]
    s_add_u32 s46, s46, s93
    v_exp_f32 v150, v46
    v_mfma_f32_16x16x32_bf16 v[56:59], a[140:143], a[92:95], v[56:59]
    s_addc_u32 s47, s47, 0
    v_exp_f32 v151, v47
    v_mfma_f32_16x16x32_bf16 v[60:63], a[144:147], a[80:83], v[72:75]
    v_cvt_pk_bf16_f32 v125, v146, v147
    v_cvt_pk_bf16_f32 v126, v148, v149
    v_mfma_f32_16x16x32_bf16 v[60:63], a[148:151], a[84:87], v[60:63]
    v_exp_f32_e64 v152, v48
    v_mfma_f32_16x16x32_bf16 v[60:63], a[152:155], a[88:91], v[60:63]
    s_mov_b32 m0, s52
    v_exp_f32 v153, v49
    v_mfma_f32_16x16x32_bf16 v[60:63], a[156:159], a[92:95], v[60:63]
    global_load_lds_dwordx4 v244, s[40:41] nt
    v_cvt_pk_bf16_f32 v127, v150, v151
    v_mfma_f32_16x16x32_bf16 v[88:91], v[96:99], v[120:123], 0
    v_exp_f32_e64 v154, v50
    v_mfma_f32_16x16x32_bf16 v[88:91], v[96:99], v[124:127], v[88:91]
    s_waitcnt lgkmcnt(0)
    v_exp_f32 v155, v51
    v_mfma_f32_16x16x32_bf16 v[184:187], a[192:195], v[112:115], v[184:187]
    v_exp_f32_e64 v156, v52
    v_mfma_f32_16x16x32_bf16 v[184:187], a[196:199], v[116:119], v[184:187]
    v_exp_f32_e64 v157, v53
    v_mfma_f32_16x16x32_bf16 v[188:191], a[200:203], v[112:115], v[188:191]
    v_exp_f32_e64 v158, v54
    v_mfma_f32_16x16x32_bf16 v[188:191], a[204:207], v[116:119], v[188:191]
    v_exp_f32_e64 v159, v55
L_slot18:
    v_mfma_f32_16x16x32_bf16 v[192:195], a[208:211], v[112:115], v[192:195]
    v_cmp_lt_f32_e64 vcc, s56, v88
    v_cvt_pk_bf16_f32 v128, v152, v153
    v_mfma_f32_16x16x32_bf16 v[192:195], a[212:215], v[116:119], v[192:195]
    s_cbranch_vccnz L_stub16
L_back16:
    v_add_f32 v101, v101, v88
    v_mfma_f32_16x16x32_bf16 v[196:199], a[216:219], v[112:115], v[196:199]
    s_waitcnt vmcnt(9)
    s_barrier
    v_cvt_pk_bf16_f32 v129, v154, v155
    v_mfma_f32_16x16x32_bf16 v[196:199], a[220:223], v[116:119], v[196:199]
    ds_read_b128 a[96:99], v232
    ds_read_b128 a[100:103], v233
    v_mfma_f32_16x16x32_bf16 a[16:19], a[160:163], v[120:123], a[16:19]
    global_load_lds_dwordx4 v245, s[40:41] offset:1024 nt
    v_cvt_pk_bf16_f32 v130, v156, v157
    v_mfma_f32_16x16x32_bf16 a[16:19], a[164:167], v[124:127], a[16:19]
    ds_read_b128 a[104:107], v234
    ds_read_b128 a[108:111], v235
    v_mfma_f32_16x16x32_bf16 a[20:23], a[168:171], v[120:123], a[20:23]
    global_load_lds_dwordx4 v246, s[40:41] offset:2048 nt
    v_cvt_pk_bf16_f32 v131, v158, v159
    v_mfma_f32_16x16x32_bf16 a[20:23], a[172:175], v[124:127], a[20:23]
    ds_read_b128 a[112:115], v232 offset:4096
    ds_read_b128 a[116:119], v233 offset:4096
    v_mfma_f32_16x16x32_bf16 a[24:27], a[176:179], v[120:123], a[24:27]
    v_exp_f32_e64 v160, v56
    v_mfma_f32_16x16x32_bf16 a[24:27], a[180:183], v[124:127], a[24:27]
    ds_read_b128 a[120:123], v234 offset:4096
    ds_read_b128 a[124:127], v235 offset:4096
    v_mfma_f32_16x16x32_bf16 a[28:31], a[184:187], v[120:123], a[28:31]
    v_exp_f32_e64 v161, v57
    v_mfma_f32_16x16x32_bf16 a[28:31], a[188:191], v[124:127], a[28:31]
    s_waitcnt lgkmcnt(6)
    ds_read_b128 a[128:131], v232 offset:8192
    ds_read_b128 a[132:135], v233 offset:8192
    v_mfma_f32_16x16x32_bf16 v[16:19], a[96:99], a[48:51], v[64:67]
    global_load_lds_dwordx4 v247, s[40:41] offset:3072 nt
    v_cvt_pk_bf16_f32 v132, v160, v161
    v_mfma_f32_16x16x32_bf16 v[16:19], a[100:103], a[52:55], v[16:19]
    s_waitcnt lgkmcnt(6)
    ds_read_b128 a[136:139], v234 offset:8192
    ds_read_b128 a[140:143], v235 offset:8192
    v_mfma_f32_16x16x32_bf16 v[16:19], a[104:107], a[56:59], v[16:19]
    v_exp_f32_e64 v162, v58
    v_mfma_f32_16x16x32_bf16 v[16:19], a[108:111], a[60:63], v[16:19]
    s_waitcnt lgkmcnt(6)
    ds_read_b128 a[144:147], v232 offset:12288
    ds_read_b128 a[148:151], v233 offset:12288
    v_mfma_f32_16x16x32_bf16 v[20:23], a[112:115], a[48:51], v[64:67]
    v_exp_f32 v163, v59
    v_mfma_f32_16x16x32_bf16 v[20:23], a[116:119], a[52:55], v[20:23]
    s_waitcnt lgkmcnt(6)
    ds_read_b128 a[152:155], v234 offset:12288
    ds_read_b128 a[156:159], v235 offset:12288
    v_mfma_f32_16x16x32_bf16 v[20:23], a[120:123], a[56:59], v[20:23]
    s_mov_b32 m0, s53
    v_exp_f32_e64 v164, v60
    v_mfma_f32_16x16x32_bf16 v[20:23], a[124:127], a[60:63], v[20:23]
    s_waitcnt lgkmcnt(6)
    global_load_lds_dwordx4 v244, s[42:43] nt
    v_cvt_pk_bf16_f32 v133, v162, v163
    v_mfma_f32_16x16x32_bf16 v[24:27], a[128:131], a[48:51], v[64:67]
    v_exp_f32 v165, v61
    v_mfma_f32_16x16x32_bf16 v[24:27], a[132:135], a[52:55], v[24:27]
    s_waitcnt lgkmcnt(4)
    v_exp_f32 v166, v62
    v_mfma_f32_16x16x32_bf16 v[24:27], a[136:139], a[56:59], v[24:27]
    v_exp_f32_e64 v167, v63
    v_mfma_f32_16x16x32_bf16 v[24:27], a[140:143], a[60:63], v[24:27]
    s_waitcnt lgkmcnt(2)
    v_exp_f32 v136, v16
    v_mfma_f32_16x16x32_bf16 v[28:31], a[144:147], a[48:51], v[64:67]
    v_exp_f32_e64 v137, v17
    v_mfma_f32_16x16x32_bf16 v[28:31], a[148:151], a[52:55], v[28:31]
    s_waitcnt lgkmcnt(0)
    global_load_lds_dwordx4 v245, s[42:43] offset:1024 nt
    v_cvt_pk_bf16_f32 v134, v164, v165
    v_mfma_f32_16x16x32_bf16 v[28:31], a[152:155], a[56:59], v[28:31]
    v_exp_f32 v138, v18
    v_mfma_f32_16x16x32_bf16 v[28:31], a[156:159], a[60:63], v[28:31]
    v_exp_f32_e64 v139, v19
    v_cvt_pk_bf16_f32 v135, v166, v167
    v_mfma_f32_16x16x32_bf16 v[88:91], v[96:99], v[128:131], 0
    v_exp_f32_e64 v140, v20
    v_mfma_f32_16x16x32_bf16 v[88:91], v[96:99], v[132:135], v[88:91]
    v_exp_f32_e64 v141, v21
    v_mfma_f32_16x16x32_bf16 v[200:203], a[192:195], v[120:123], v[200:203]
    v_exp_f32_e64 v142, v22
    v_mfma_f32_16x16x32_bf16 v[200:203], a[196:199], v[124:127], v[200:203]
    global_load_lds_dwordx4 v246, s[42:43] offset:2048 nt
    v_cvt_pk_bf16_f32 v112, v136, v137
    v_mfma_f32_16x16x32_bf16 v[204:207], a[200:203], v[120:123], v[204:207]
    v_exp_f32_e64 v143, v23
    v_mfma_f32_16x16x32_bf16 v[204:207], a[204:207], v[124:127], v[204:207]
    v_exp_f32_e64 v144, v24
L_slot19:
    v_mfma_f32_16x16x32_bf16 v[208:211], a[208:211], v[120:123], v[208:211]
    v_cmp_lt_f32_e64 vcc, s56, v88
    v_cvt_pk_bf16_f32 v113, v138, v139
    v_mfma_f32_16x16x32_bf16 v[208:211], a[212:215], v[124:127], v[208:211]
    s_cbranch_vccnz L_stub17
L_back17:
    v_add_f32 v102, v102, v88
    v_mfma_f32_16x16x32_bf16 v[212:215], a[216:219], v[120:123], v[212:215]
    v_exp_f32_e64 v145, v25
    v_mfma_f32_16x16x32_bf16 v[212:215], a[220:223], v[124:127], v[212:215]
    v_exp_f32_e64 v146, v26
    v_mfma_f32_16x16x32_bf16 a[32:35], a[160:163], v[128:131], a[32:35]
    global_load_lds_dwordx4 v247, s[42:43] offset:3072 nt
    v_cvt_pk_bf16_f32 v114, v140, v141
    v_mfma_f32_16x16x32_bf16 a[32:35], a[164:167], v[132:135], a[32:35]
    v_exp_f32_e64 v147, v27
    v_mfma_f32_16x16x32_bf16 a[36:39], a[168:171], v[128:131], a[36:39]
    v_exp_f32_e64 v148, v28
    v_mfma_f32_16x16x32_bf16 a[36:39], a[172:175], v[132:135], a[36:39]
    v_exp_f32_e64 v149, v29
    v_mfma_f32_16x16x32_bf16 a[40:43], a[176:179], v[128:131], a[40:43]
    v_exp_f32_e64 v150, v30
    v_mfma_f32_16x16x32_bf16 a[40:43], a[180:183], v[132:135], a[40:43]
    s_mov_b32 m0, s54
    v_exp_f32 v151, v31
    v_mfma_f32_16x16x32_bf16 a[44:47], a[184:187], v[128:131], a[44:47]
    global_load_lds_dwordx4 v248, s[44:45] nt
    v_cvt_pk_bf16_f32 v115, v142, v143
    v_mfma_f32_16x16x32_bf16 a[44:47], a[188:191], v[132:135], a[44:47]
    v_cvt_pk_bf16_f32 v116, v144, v145
    v_cvt_pk_bf16_f32 v117, v146, v147
    v_mfma_f32_16x16x32_bf16 v[32:35], a[96:99], a[64:67], v[68:71]
    v_cvt_pk_bf16_f32 v118, v148, v149
    v_cvt_pk_bf16_f32 v119, v150, v151
    v_mfma_f32_16x16x32_bf16 v[32:35], a[100:103], a[68:71], v[32:35]
    v_mfma_f32_16x16x32_bf16 v[32:35], a[104:107], a[72:75], v[32:35]
    v_mfma_f32_16x16x32_bf16 v[32:35], a[108:111], a[76:79], v[32:35]
    s_waitcnt vmcnt(9)
    s_barrier
    v_mfma_f32_16x16x32_bf16 v[36:39], a[112:115], a[64:67], v[68:71]
    ds_read_b64_tr_b16 a[160:161], v240 offset:16384
    ds_read_b64_tr_b16 a[162:163], v240 offset:20480
    v_mfma_f32_16x16x32_bf16 v[36:39], a[116:119], a[68:71], v[36:39]
    global_load_lds_dwordx4 v249, s[44:45] offset:1024 nt
    v_mfma_f32_16x16x32_bf16 v[36:39], a[120:123], a[72:75], v[36:39]
    ds_read_b64_tr_b16 a[164:165], v240 offset:24576
    ds_read_b64_tr_b16 a[166:167], v240 offset:28672
    v_mfma_f32_16x16x32_bf16 v[36:39], a[124:127], a[76:79], v[36:39]
    v_mfma_f32_16x16x32_bf16 v[40:43], a[128:131], a[64:67], v[68:71]
    ds_read_b64_tr_b16 a[168:169], v241 offset:16384
    ds_read_b64_tr_b16 a[170:171], v241 offset:20480
    v_mfma_f32_16x16x32_bf16 v[40:43], a[132:135], a[68:71], v[40:43]
    v_exp_f32_e64 v152, v32
    v_mfma_f32_16x16x32_bf16 v[40:43], a[136:139], a[72:75], v[40:43]
    ds_read_b64_tr_b16 a[172:173], v241 offset:24576
    ds_read_b64_tr_b16 a[174:175], v241 offset:28672
    v_mfma_f32_16x16x32_bf16 v[40:43], a[140:143], a[76:79], v[40:43]
    global_load_lds_dwordx4 v248, s[44:45] offset:2048 nt
    v_mfma_f32_16x16x32_bf16 v[44:47], a[144:147], a[64:67], v[68:71]
    ds_read_b64_tr_b16 a[176:177], v242 offset:16384
    ds_read_b64_tr_b16 a[178:179], v242 offset:20480
    v_mfma_f32_16x16x32_bf16 v[44:47], a[148:151], a[68:71], v[44:47]
    v_exp_f32_e64 v153, v33
    v_mfma_f32_16x16x32_bf16 v[44:47], a[152:155], a[72:75], v[44:47]
    ds_read_b64_tr_b16 a[180:181], v242 offset:24576
    ds_read_b64_tr_b16 a[182:183], v242 offset:28672
    v_mfma_f32_16x16x32_bf16 v[44:47], a[156:159], a[76:79], v[44:47]
    v_exp_f32_e64 v154, v34
    v_mfma_f32_16x16x32_bf16 v[88:91], v[96:99], v[112:115], 0
    ds_read_b64_tr_b16 a[184:185], v243 offset:16384
    ds_read_b64_tr_b16 a[186:187], v243 offset:20480
    v_mfma_f32_16x16x32_bf16 v[88:91], v[96:99], v[116:119], v[88:91]
    global_load_lds_dwordx4 v249, s[44:45] offset:3072 nt
    v_cvt_pk_bf16_f32 v120, v152, v153
    v_mfma_f32_16x16x32_bf16 v[216:219], a[192:195], v[128:131], v[216:219]
    ds_read_b64_tr_b16 a[188:189], v243 offset:24576
    ds_read_b64_tr_b16 a[190:191], v243 offset:28672
    v_mfma_f32_16x16x32_bf16 v[216:219], a[196:199], v[132:135], v[216:219]
    v_exp_f32_e64 v155, v35
    v_mfma_f32_16x16x32_bf16 v[220:223], a[200:203], v[128:131], v[220:223]
    ds_read_b64_tr_b16 a[192:193], v236 offset:16384
    ds_read_b64_tr_b16 a[194:195], v236 offset:20480
    v_mfma_f32_16x16x32_bf16 v[220:223], a[204:207], v[132:135], v[220:223]
    v_exp_f32_e64 v156, v36
L_slot20:
    v_mfma_f32_16x16x32_bf16 v[224:227], a[208:211], v[128:131], v[224:227]
    v_cmp_lt_f32_e64 vcc, s56, v88
    v_cvt_pk_bf16_f32 v121, v154, v155
    v_mfma_f32_16x16x32_bf16 v[224:227], a[212:215], v[132:135], v[224:227]
    s_cbranch_vccnz L_stub18
L_back18:
    v_add_f32 v100, v100, v88
    v_mfma_f32_16x16x32_bf16 v[228:231], a[216:219], v[128:131], v[228:231]
    s_mov_b32 m0, s55
    ds_read_b64_tr_b16 a[196:197], v236 offset:24576
    ds_read_b64_tr_b16 a[198:199], v236 offset:28672
    v_mfma_f32_16x16x32_bf16 v[228:231], a[220:223], v[132:135], v[228:231]
    s_waitcnt lgkmcnt(6)
    global_load_lds_dwordx4 v248, s[46:47] nt
    v_mfma_f32_16x16x32_bf16 a[0:3], a[160:163], v[112:115], a[0:3]
    ds_read_b64_tr_b16 a[200:201], v237 offset:16384
    ds_read_b64_tr_b16 a[202:203], v237 offset:20480
    v_mfma_f32_16x16x32_bf16 a[0:3], a[164:167], v[116:119], a[0:3]
    v_exp_f32_e64 v157, v37
    v_mfma_f32_16x16x32_bf16 a[4:7], a[168:171], v[112:115], a[4:7]
    ds_read_b64_tr_b16 a[204:205], v237 offset:24576
    ds_read_b64_tr_b16 a[206:207], v237 offset:28672
    v_mfma_f32_16x16x32_bf16 a[4:7], a[172:175], v[116:119], a[4:7]
    v_exp_f32_e64 v158, v38
    v_mfma_f32_16x16x32_bf16 a[8:11], a[176:179], v[112:115], a[8:11]
    ds_read_b64_tr_b16 a[208:209], v238 offset:16384
    ds_read_b64_tr_b16 a[210:211], v238 offset:20480
    v_mfma_f32_16x16x32_bf16 a[8:11], a[180:183], v[116:119], a[8:11]
    global_load_lds_dwordx4 v249, s[46:47] offset:1024 nt
    v_cvt_pk_bf16_f32 v122, v156, v157
    v_mfma_f32_16x16x32_bf16 a[12:15], a[184:187], v[112:115], a[12:15]
    s_waitcnt lgkmcnt(10)
    ds_read_b64_tr_b16 a[212:213], v238 offset:24576
    ds_read_b64_tr_b16 a[214:215], v238 offset:28672
    v_mfma_f32_16x16x32_bf16 a[12:15], a[188:191], v[116:119], a[12:15]
    v_exp_f32 v159, v39
    v_mfma_f32_16x16x32_bf16 v[48:51], a[96:99], a[80:83], v[72:75]
    ds_read_b64_tr_b16 a[216:217], v239 offset:16384
    ds_read_b64_tr_b16 a[218:219], v239 offset:20480
    v_mfma_f32_16x16x32_bf16 v[48:51], a[100:103], a[84:87], v[48:51]
    v_exp_f32_e64 v160, v40
    v_mfma_f32_16x16x32_bf16 v[48:51], a[104:107], a[88:91], v[48:51]
    ds_read_b64_tr_b16 a[220:221], v239 offset:24576
    ds_read_b64_tr_b16 a[222:223], v239 offset:28672
    v_mfma_f32_16x16x32_bf16 v[48:51], a[108:111], a[92:95], v[48:51]
    global_load_lds_dwordx4 v248, s[46:47] offset:2048 nt
    v_cvt_pk_bf16_f32 v123, v158, v159
    v_mfma_f32_16x16x32_bf16 v[52:55], a[112:115], a[80:83], v[72:75]
    v_exp_f32_e64 v161, v41
    v_mfma_f32_16x16x32_bf16 v[52:55], a[116:119], a[84:87], v[52:55]
    v_exp_f32_e64 v162, v42
    v_mfma_f32_16x16x32_bf16 v[52:55], a[120:123], a[88:91], v[52:55]
    v_exp_f32_e64 v163, v43
    v_mfma_f32_16x16x32_bf16 v[52:55], a[124:127], a[92:95], v[52:55]
    v_exp_f32_e64 v164, v44
    v_mfma_f32_16x16x32_bf16 v[56:59], a[128:131], a[80:83], v[72:75]
    v_exp_f32_e64 v165, v45
    v_mfma_f32_16x16x32_bf16 v[56:59], a[132:135], a[84:87], v[56:59]
    global_load_lds_dwordx4 v249, s[46:47] offset:3072 nt
    v_cvt_pk_bf16_f32 v124, v160, v161
    v_mfma_f32_16x16x32_bf16 v[56:59], a[136:139], a[88:91], v[56:59]
    v_exp_f32_e64 v166, v46
    v_mfma_f32_16x16x32_bf16 v[56:59], a[140:143], a[92:95], v[56:59]
    v_exp_f32_e64 v167, v47
    v_mfma_f32_16x16x32_bf16 v[60:63], a[144:147], a[80:83], v[72:75]
    v_cvt_pk_bf16_f32 v125, v162, v163
    v_cvt_pk_bf16_f32 v126, v164, v165
    v_mfma_f32_16x16x32_bf16 v[60:63], a[148:151], a[84:87], v[60:63]
    v_exp_f32_e64 v136, v48
    v_mfma_f32_16x16x32_bf16 v[60:63], a[152:155], a[88:91], v[60:63]
    v_exp_f32_e64 v137, v49
    v_mfma_f32_16x16x32_bf16 v[60:63], a[156:159], a[92:95], v[60:63]
    v_exp_f32_e64 v138, v50
    v_cvt_pk_bf16_f32 v127, v166, v167
    v_mfma_f32_16x16x32_bf16 v[88:91], v[96:99], v[120:123], 0
    v_exp_f32_e64 v139, v51
    v_mfma_f32_16x16x32_bf16 v[88:91], v[96:99], v[124:127], v[88:91]
    s_waitcnt lgkmcnt(0)
    v_exp_f32 v140, v52
    v_mfma_f32_16x16x32_bf16 v[184:187], a[192:195], v[112:115], v[184:187]
    v_exp_f32_e64 v141, v53
    v_mfma_f32_16x16x32_bf16 v[184:187], a[196:199], v[116:119], v[184:187]
    v_exp_f32_e64 v142, v54
    v_mfma_f32_16x16x32_bf16 v[188:191], a[200:203], v[112:115], v[188:191]
    v_exp_f32_e64 v143, v55
    v_mfma_f32_16x16x32_bf16 v[188:191], a[204:207], v[116:119], v[188:191]
    v_exp_f32_e64 v144, v56
L_slot21:
    v_mfma_f32_16x16x32_bf16 v[192:195], a[208:211], v[112:115], v[192:195]
    v_cmp_lt_f32_e64 vcc, s56, v88
    v_cvt_pk_bf16_f32 v128, v136, v137
    v_mfma_f32_16x16x32_bf16 v[192:195], a[212:215], v[116:119], v[192:195]
    s_cbranch_vccnz L_stub19
L_back19:
    v_add_f32 v101, v101, v88
    v_mfma_f32_16x16x32_bf16 v[196:199], a[216:219], v[112:115], v[196:199]
    s_waitcnt vmcnt(8)
    s_barrier
    v_cvt_pk_bf16_f32 v129, v138, v139
    v_mfma_f32_16x16x32_bf16 v[196:199], a[220:223], v[116:119], v[196:199]
    ds_read_b128 a[96:99], v232 offset:32768
    ds_read_b128 a[100:103], v233 offset:32768
    v_mfma_f32_16x16x32_bf16 a[16:19], a[160:163], v[120:123], a[16:19]
    v_exp_f32_e64 v145, v57
    v_mfma_f32_16x16x32_bf16 a[16:19], a[164:167], v[124:127], a[16:19]
    ds_read_b128 a[104:107], v234 offset:32768
    ds_read_b128 a[108:111], v235 offset:32768
    v_mfma_f32_16x16x32_bf16 a[20:23], a[168:171], v[120:123], a[20:23]
    v_exp_f32_e64 v146, v58
    v_mfma_f32_16x16x32_bf16 a[20:23], a[172:175], v[124:127], a[20:23]
    ds_read_b128 a[112:115], v232 offset:36864
    ds_read_b128 a[116:119], v233 offset:36864
    v_mfma_f32_16x16x32_bf16 a[24:27], a[176:179], v[120:123], a[24:27]
    v_exp_f32_e64 v147, v59
    v_mfma_f32_16x16x32_bf16 a[24:27], a[180:183], v[124:127], a[24:27]
    ds_read_b128 a[120:123], v234 offset:36864
    ds_read_b128 a[124:127], v235 offset:36864
    v_mfma_f32_16x16x32_bf16 a[28:31], a[184:187], v[120:123], a[28:31]
    v_exp_f32_e64 v148, v60
    v_mfma_f32_16x16x32_bf16 a[28:31], a[188:191], v[124:127], a[28:31]
    s_waitcnt lgkmcnt(6)
    ds_read_b128 a[128:131], v232 offset:40960
    ds_read_b128 a[132:135], v233 offset:40960
    v_mfma_f32_16x16x32_bf16 v[16:19], a[96:99], a[48:51], v[64:67]
    v_exp_f32 v149, v61
    v_mfma_f32_16x16x32_bf16 v[16:19], a[100:103], a[52:55], v[16:19]
    s_waitcnt lgkmcnt(6)
    ds_read_b128 a[136:139], v234 offset:40960
    ds_read_b128 a[140:143], v235 offset:40960
    v_mfma_f32_16x16x32_bf16 v[16:19], a[104:107], a[56:59], v[16:19]
    v_exp_f32 v150, v62
    v_mfma_f32_16x16x32_bf16 v[16:19], a[108:111], a[60:63], v[16:19]
    s_waitcnt lgkmcnt(6)
    ds_read_b128 a[144:147], v232 offset:45056
    ds_read_b128 a[148:151], v233 offset:45056
    v_mfma_f32_16x16x32_bf16 v[20:23], a[112:115], a[48:51], v[64:67]
    v_exp_f32 v151, v63
    v_mfma_f32_16x16x32_bf16 v[20:23], a[116:119], a[52:55], v[20:23]
    s_waitcnt lgkmcnt(6)
    ds_read_b128 a[152:155], v234 offset:45056
    ds_read_b128 a[156:159], v235 offset:45056
    v_mfma_f32_16x16x32_bf16 v[20:23], a[120:123], a[56:59], v[20:23]
    v_cvt_pk_bf16_f32 v130, v140, v141
    v_cvt_pk_bf16_f32 v131, v142, v143
    v_mfma_f32_16x16x32_bf16 v[20:23], a[124:127], a[60:63], v[20:23]
L_hook4:
    s_cbranch_execz L_warm_ret
    s_nop 0
    s_waitcnt lgkmcnt(6)
    v_cvt_pk_bf16_f32 v132, v144, v145
    v_cvt_pk_bf16_f32 v133, v146, v147
    v_mfma_f32_16x16x32_bf16 v[24:27], a[128:131], a[48:51], v[64:67]
    v_cvt_pk_bf16_f32 v134, v148, v149
    v_cvt_pk_bf16_f32 v135, v150, v151
    v_mfma_f32_16x16x32_bf16 v[24:27], a[132:135], a[52:55], v[24:27]
    s_waitcnt lgkmcnt(4)
    v_exp_f32 v152, v16
    v_mfma_f32_16x16x32_bf16 v[24:27], a[136:139], a[56:59], v[24:27]
    v_exp_f32_e64 v153, v17
    v_mfma_f32_16x16x32_bf16 v[24:27], a[140:143], a[60:63], v[24:27]
    s_waitcnt lgkmcnt(2)
    v_exp_f32 v154, v18
    v_mfma_f32_16x16x32_bf16 v[28:31], a[144:147], a[48:51], v[64:67]
    v_exp_f32_e64 v155, v19
    v_mfma_f32_16x16x32_bf16 v[28:31], a[148:151], a[52:55], v[28:31]
    s_waitcnt lgkmcnt(0)
    v_exp_f32 v156, v20
    v_mfma_f32_16x16x32_bf16 v[28:31], a[152:155], a[56:59], v[28:31]
    v_exp_f32_e64 v157, v21
    v_mfma_f32_16x16x32_bf16 v[28:31], a[156:159], a[60:63], v[28:31]
    v_exp_f32_e64 v158, v22
    v_mfma_f32_16x16x32_bf16 v[88:91], v[96:99], v[128:131], 0
    v_exp_f32_e64 v159, v23
    v_mfma_f32_16x16x32_bf16 v[88:91], v[96:99], v[132:135], v[88:91]
    v_exp_f32_e64 v160, v24
    v_mfma_f32_16x16x32_bf16 v[200:203], a[192:195], v[120:123], v[200:203]
    v_exp_f32_e64 v161, v25
    v_mfma_f32_16x16x32_bf16 v[200:203], a[196:199], v[124:127], v[200:203]
    v_exp_f32_e64 v162, v26
    v_mfma_f32_16x16x32_bf16 v[204:207], a[200:203], v[120:123], v[204:207]
    v_exp_f32_e64 v163, v27
    v_mfma_f32_16x16x32_bf16 v[204:207], a[204:207], v[124:127], v[204:207]
    v_exp_f32_e64 v164, v28
L_slot22:
    v_mfma_f32_16x16x32_bf16 v[208:211], a[208:211], v[120:123], v[208:211]
    v_cmp_lt_f32_e64 vcc, s56, v88
    v_cvt_pk_bf16_f32 v112, v152, v153
    v_mfma_f32_16x16x32_bf16 v[208:211], a[212:215], v[124:127], v[208:211]
    s_cbranch_vccnz L_stub20
L_back20:
    v_add_f32 v102, v102, v88
    v_mfma_f32_16x16x32_bf16 v[212:215], a[216:219], v[120:123], v[212:215]
    v_exp_f32_e64 v165, v29
    v_mfma_f32_16x16x32_bf16 v[212:215], a[220:223], v[124:127], v[212:215]
    v_exp_f32_e64 v166, v30
    v_mfma_f32_16x16x32_bf16 a[32:35], a[160:163], v[128:131], a[32:35]
    v_exp_f32_e64 v167, v31
    v_mfma_f32_16x16x32_bf16 a[32:35], a[164:167], v[132:135], a[32:35]
    v_cvt_pk_bf16_f32 v113, v154, v155
    v_cvt_pk_bf16_f32 v114, v156, v157
    v_mfma_f32_16x16x32_bf16 a[36:39], a[168:171], v[128:131], a[36:39]
    v_cvt_pk_bf16_f32 v115, v158, v159
    v_cvt_pk_bf16_f32 v116, v160, v161
    v_mfma_f32_16x16x32_bf16 a[36:39], a[172:175], v[132:135], a[36:39]
    v_cvt_pk_bf16_f32 v117, v162, v163
    v_cvt_pk_bf16_f32 v118, v164, v165
    v_mfma_f32_16x16x32_bf16 a[40:43], a[176:179], v[128:131], a[40:43]
    v_cvt_pk_bf16_f32 v119, v166, v167
    v_mfma_f32_16x16x32_bf16 a[40:43], a[180:183], v[132:135], a[40:43]
    v_mfma_f32_16x16x32_bf16 a[44:47], a[184:187], v[128:131], a[44:47]
    v_mfma_f32_16x16x32_bf16 a[44:47], a[188:191], v[132:135], a[44:47]
    v_mfma_f32_16x16x32_bf16 v[32:35], a[96:99], a[64:67], v[68:71]
    v_mfma_f32_16x16x32_bf16 v[32:35], a[100:103], a[68:71], v[32:35]
    v_mfma_f32_16x16x32_bf16 v[32:35], a[104:107], a[72:75], v[32:35]
    v_mfma_f32_16x16x32_bf16 v[32:35], a[108:111], a[76:79], v[32:35]
    s_waitcnt vmcnt(0)
    s_barrier
    v_mfma_f32_16x16x32_bf16 v[36:39], a[112:115], a[64:67], v[68:71]
    ds_read_b64_tr_b16 a[160:161], v240 offset:49152
    ds_read_b64_tr_b16 a[162:163], v240 offset:53248
    v_mfma_f32_16x16x32_bf16 v[36:39], a[116:119], a[68:71], v[36:39]
    v_mfma_f32_16x16x32_bf16 v[36:39], a[120:123], a[72:75], v[36:39]
    ds_read_b64_tr_b16 a[164:165], v240 offset:57344
    ds_read_b64_tr_b16 a[166:167], v240 offset:61440
    v_mfma_f32_16x16x32_bf16 v[36:39], a[124:127], a[76:79], v[36:39]
    v_mfma_f32_16x16x32_bf16 v[40:43], a[128:131], a[64:67], v[68:71]
    ds_read_b64_tr_b16 a[168:169], v241 offset:49152
    ds_read_b64_tr_b16 a[170:171], v241 offset:53248
    v_mfma_f32_16x16x32_bf16 v[40:43], a[132:135], a[68:71], v[40:43]
    v_exp_f32_e64 v136, v32
    v_mfma_f32_16x16x32_bf16 v[40:43], a[136:139], a[72:75], v[40:43]
    ds_read_b64_tr_b16 a[172:173], v241 offset:57344
    ds_read_b64_tr_b16 a[174:175], v241 offset:61440
    v_mfma_f32_16x16x32_bf16 v[40:43], a[140:143], a[76:79], v[40:43]
    v_exp_f32_e64 v137, v33
    v_mfma_f32_16x16x32_bf16 v[44:47], a[144:147], a[64:67], v[68:71]
    ds_read_b64_tr_b16 a[176:177], v242 offset:49152
    ds_read_b64_tr_b16 a[178:179], v242 offset:53248
    v_mfma_f32_16x16x32_bf16 v[44:47], a[148:151], a[68:71], v[44:47]
    v_exp_f32_e64 v138, v34
    v_mfma_f32_16x16x32_bf16 v[44:47], a[152:155], a[72:75], v[44:47]
    ds_read_b64_tr_b16 a[180:181], v242 offset:57344
    ds_read_b64_tr_b16 a[182:183], v242 offset:61440
    v_mfma_f32_16x16x32_bf16 v[44:47], a[156:159], a[76:79], v[44:47]
    v_exp_f32_e64 v139, v35
    v_mfma_f32_16x16x32_bf16 v[88:91], v[96:99], v[112:115], 0
    ds_read_b64_tr_b16 a[184:185], v243 offset:49152
    ds_read_b64_tr_b16 a[186:187], v243 offset:53248
    v_mfma_f32_16x16x32_bf16 v[88:91], v[96:99], v[116:119], v[88:91]
    v_exp_f32_e64 v140, v36
    v_mfma_f32_16x16x32_bf16 v[216:219], a[192:195], v[128:131], v[216:219]
    ds_read_b64_tr_b16 a[188:189], v243 offset:57344
    ds_read_b64_tr_b16 a[190:191], v243 offset:61440
    v_mfma_f32_16x16x32_bf16 v[216:219], a[196:199], v[132:135], v[216:219]
    ds_read_b64_tr_b16 a[192:193], v236 offset:49152
    ds_read_b64_tr_b16 a[194:195], v236 offset:53248
    v_mfma_f32_16x16x32_bf16 v[220:223], a[200:203], v[128:131], v[220:223]
    ds_read_b64_tr_b16 a[196:197], v236 offset:57344
    ds_read_b64_tr_b16 a[198:199], v236 offset:61440
    v_mfma_f32_16x16x32_bf16 v[220:223], a[204:207], v[132:135], v[220:223]
    ds_read_b64_tr_b16 a[200:201], v237 offset:49152
    ds_read_b64_tr_b16 a[202:203], v237 offset:53248
L_slot23:
    v_mfma_f32_16x16x32_bf16 v[224:227], a[208:211], v[128:131], v[224:227]
    v_cmp_lt_f32_e64 vcc, s56, v88
    v_cvt_pk_bf16_f32 v120, v136, v137
    v_mfma_f32_16x16x32_bf16 v[224:227], a[212:215], v[132:135], v[224:227]
    s_cbranch_vccnz L_stub21
L_back21:
    v_add_f32 v100, v100, v88
    v_mfma_f32_16x16x32_bf16 v[228:231], a[216:219], v[128:131], v[228:231]
    ds_read_b64_tr_b16 a[204:205], v237 offset:57344
    ds_read_b64_tr_b16 a[206:207], v237 offset:61440
    v_mfma_f32_16x16x32_bf16 v[228:231], a[220:223], v[132:135], v[228:231]
    s_waitcnt lgkmcnt(10)
    ds_read_b64_tr_b16 a[208:209], v238 offset:49152
    ds_read_b64_tr_b16 a[210:211], v238 offset:53248
    v_mfma_f32_16x16x32_bf16 a[0:3], a[160:163], v[112:115], a[0:3]
    ds_read_b64_tr_b16 a[212:213], v238 offset:57344
    ds_read_b64_tr_b16 a[214:215], v238 offset:61440
    v_mfma_f32_16x16x32_bf16 a[0:3], a[164:167], v[116:119], a[0:3]
    ds_read_b64_tr_b16 a[216:217], v239 offset:49152
    ds_read_b64_tr_b16 a[218:219], v239 offset:53248
    v_mfma_f32_16x16x32_bf16 a[4:7], a[168:171], v[112:115], a[4:7]
    ds_read_b64_tr_b16 a[220:221], v239 offset:57344
    ds_read_b64_tr_b16 a[222:223], v239 offset:61440
    v_mfma_f32_16x16x32_bf16 a[4:7], a[172:175], v[116:119], a[4:7]
    v_exp_f32 v141, v37
    v_mfma_f32_16x16x32_bf16 a[8:11], a[176:179], v[112:115], a[8:11]
    v_exp_f32_e64 v142, v38
    v_mfma_f32_16x16x32_bf16 a[8:11], a[180:183], v[116:119], a[8:11]
    v_exp_f32_e64 v143, v39
    v_mfma_f32_16x16x32_bf16 a[12:15], a[184:187], v[112:115], a[12:15]
    s_waitcnt lgkmcnt(14)
    v_exp_f32 v144, v40
    v_mfma_f32_16x16x32_bf16 a[12:15], a[188:191], v[116:119], a[12:15]
    v_exp_f32_e64 v145, v41
    v_mfma_f32_16x16x32_bf16 v[48:51], a[96:99], a[80:83], v[72:75]
    ds_write_b128 v104, a[0:3]
    v_mfma_f32_16x16x32_bf16 v[48:51], a[100:103], a[84:87], v[48:51]
    v_cvt_pk_bf16_f32 v121, v138, v139
    v_cvt_pk_bf16_f32 v122, v140, v141
    v_mfma_f32_16x16x32_bf16 v[48:51], a[104:107], a[88:91], v[48:51]
    v_exp_f32_e64 v146, v42
    v_mfma_f32_16x16x32_bf16 v[48:51], a[108:111], a[92:95], v[48:51]
    ds_write_b128 v104, a[4:7] offset:1024
    v_mfma_f32_16x16x32_bf16 v[52:55], a[112:115], a[80:83], v[72:75]
    v_exp_f32_e64 v147, v43
    v_mfma_f32_16x16x32_bf16 v[52:55], a[116:119], a[84:87], v[52:55]
    v_exp_f32_e64 v148, v44
    v_mfma_f32_16x16x32_bf16 v[52:55], a[120:123], a[88:91], v[52:55]
    ds_write_b128 v104, a[8:11] offset:2048
    v_mfma_f32_16x16x32_bf16 v[52:55], a[124:127], a[92:95], v[52:55]
    v_exp_f32_e64 v149, v45
    v_mfma_f32_16x16x32_bf16 v[56:59], a[128:131], a[80:83], v[72:75]
    v_cvt_pk_bf16_f32 v123, v142, v143
    v_cvt_pk_bf16_f32 v124, v144, v145
    v_mfma_f32_16x16x32_bf16 v[56:59], a[132:135], a[84:87], v[56:59]
    ds_write_b128 v104, a[12:15] offset:3072
    v_mfma_f32_16x16x32_bf16 v[56:59], a[136:139], a[88:91], v[56:59]
    v_exp_f32_e64 v150, v46
    v_mfma_f32_16x16x32_bf16 v[56:59], a[140:143], a[92:95], v[56:59]
    v_exp_f32_e64 v151, v47
    v_mfma_f32_16x16x32_bf16 v[60:63], a[144:147], a[80:83], v[72:75]
    v_exp_f32_e64 v152, v48
    v_mfma_f32_16x16x32_bf16 v[60:63], a[148:151], a[84:87], v[60:63]
    v_exp_f32_e64 v153, v49
    v_cvt_pk_bf16_f32 v125, v146, v147
    v_cvt_pk_bf16_f32 v126, v148, v149
    v_cvt_pk_bf16_f32 v127, v150, v151
    s_waitcnt lgkmcnt(4)
    s_nop 0
    v_mfma_f32_16x16x32_bf16 v[60:63], a[152:155], a[88:91], v[60:63]
    v_exp_f32_e64 v154, v50
    v_mfma_f32_16x16x32_bf16 v[88:91], v[96:99], v[120:123], 0
    v_exp_f32_e64 v155, v51
    v_mfma_f32_16x16x32_bf16 v[88:91], v[96:99], v[124:127], v[88:91]
    v_exp_f32_e64 v156, v52
    v_mfma_f32_16x16x32_bf16 v[60:63], a[156:159], a[92:95], v[60:63]
    v_exp_f32_e64 v157, v53
    v_mfma_f32_16x16x32_bf16 v[184:187], a[192:195], v[112:115], v[184:187]
    v_exp_f32_e64 v158, v54
    v_mfma_f32_16x16x32_bf16 v[184:187], a[196:199], v[116:119], v[184:187]
    v_exp_f32_e64 v159, v55
    v_mfma_f32_16x16x32_bf16 v[188:191], a[200:203], v[112:115], v[188:191]
    v_cvt_pk_bf16_f32 v128, v152, v153
    v_cvt_pk_bf16_f32 v129, v154, v155
    v_mfma_f32_16x16x32_bf16 v[188:191], a[204:207], v[116:119], v[188:191]
    v_exp_f32 v160, v56
    v_cmp_lt_f32 vcc, s56, v88
    v_mfma_f32_16x16x32_bf16 v[192:195], a[208:211], v[112:115], v[192:195]
    s_cbranch_vccnz L_stub22
L_back22:
    v_add_f32 v101, v101, v88
    v_mov_b32 v65, v100
    v_mov_b32 v69, v101
    v_mfma_f32_16x16x32_bf16 a[16:19], a[160:163], v[120:123], a[16:19]
    ds_write_b64 v105, v[64:65] offset:12288
    ds_write_b64 v105, v[68:69] offset:12800
    v_mfma_f32_16x16x32_bf16 a[16:19], a[164:167], v[124:127], a[16:19]
    v_exp_f32_e64 v161, v57
    v_mfma_f32_16x16x32_bf16 a[20:23], a[168:171], v[120:123], a[20:23]
    v_exp_f32_e64 v162, v58
    v_mfma_f32_16x16x32_bf16 a[20:23], a[172:175], v[124:127], a[20:23]
    v_exp_f32_e64 v163, v59
    v_mfma_f32_16x16x32_bf16 a[24:27], a[176:179], v[120:123], a[24:27]
    v_cvt_pk_bf16_f32 v130, v156, v157
    v_cvt_pk_bf16_f32 v131, v158, v159
    v_mfma_f32_16x16x32_bf16 a[24:27], a[180:183], v[124:127], a[24:27]
    ds_write_b128 v104, a[16:19] offset:4096
    v_mfma_f32_16x16x32_bf16 a[28:31], a[184:187], v[120:123], a[28:31]
    v_exp_f32_e64 v164, v60
    v_mfma_f32_16x16x32_bf16 a[28:31], a[188:191], v[124:127], a[28:31]
    v_exp_f32_e64 v165, v61
    v_mfma_f32_16x16x32_bf16 v[192:195], a[212:215], v[116:119], v[192:195]
    ds_write_b128 v104, a[20:23] offset:5120
    v_mfma_f32_16x16x32_bf16 v[196:199], a[216:219], v[112:115], v[196:199]
    v_exp_f32_e64 v166, v62
    v_mfma_f32_16x16x32_bf16 v[196:199], a[220:223], v[116:119], v[196:199]
    v_exp_f32_e64 v167, v63
    v_mfma_f32_16x16x32_bf16 v[200:203], a[192:195], v[120:123], v[200:203]
    ds_write_b128 v104, a[24:27] offset:6144
    v_mfma_f32_16x16x32_bf16 v[200:203], a[196:199], v[124:127], v[200:203]
    v_cvt_pk_bf16_f32 v132, v160, v161
    v_cvt_pk_bf16_f32 v133, v162, v163
    v_mfma_f32_16x16x32_bf16 v[204:207], a[200:203], v[120:123], v[204:207]
    v_cvt_pk_bf16_f32 v134, v164, v165
    v_cvt_pk_bf16_f32 v135, v166, v167
    v_mfma_f32_16x16x32_bf16 v[204:207], a[204:207], v[124:127], v[204:207]
    ds_write_b128 v104, a[28:31] offset:7168
    v_mfma_f32_16x16x32_bf16 v[208:211], a[208:211], v[120:123], v[208:211]
    v_mfma_f32_16x16x32_bf16 v[88:91], v[96:99], v[128:131], 0
    v_mfma_f32_16x16x32_bf16 v[88:91], v[96:99], v[132:135], v[88:91]
    s_waitcnt lgkmcnt(0)
    s_barrier
    v_mfma_f32_16x16x32_bf16 v[208:211], a[212:215], v[124:127], v[208:211]
    ds_read_b64 v[66:67], v107 offset:12288
    ds_read_b64 v[70:71], v107 offset:12800
    v_mfma_f32_16x16x32_bf16 v[212:215], a[216:219], v[120:123], v[212:215]
    ds_read_b128 v[136:139], v106
    ds_read_b128 v[140:143], v106 offset:1024
    ds_read_b128 v[144:147], v106 offset:2048
    ds_read_b128 v[148:151], v106 offset:3072
    v_cmp_lt_f32_e64 vcc, s56, v88
    v_mfma_f32_16x16x32_bf16 v[212:215], a[220:223], v[124:127], v[212:215]
    s_cbranch_vccnz L_stub23
L_back23:
    v_add_f32 v102, v102, v88
    v_mov_b32_e64 v73, v102
    v_mfma_f32_16x16x32_bf16 a[32:35], a[160:163], v[128:131], a[32:35]
    ds_write_b64 v105, v[72:73] offset:13312
    v_mfma_f32_16x16x32_bf16 a[32:35], a[164:167], v[132:135], a[32:35]
    ds_read_b128 v[152:155], v106 offset:4096
    ds_read_b128 v[156:159], v106 offset:5120
    ds_read_b128 v[160:163], v106 offset:6144
    ds_read_b128 v[164:167], v106 offset:7168
    v_mfma_f32_16x16x32_bf16 a[36:39], a[168:171], v[128:131], a[36:39]
    s_waitcnt lgkmcnt(10)
    v_min_f32 v10, v64, v66
    s_waitcnt lgkmcnt(9)
    v_min_f32 v11, v68, v70
    v_mfma_f32_16x16x32_bf16 a[36:39], a[172:175], v[132:135], a[36:39]
    ds_write_b128 v104, a[32:35] offset:8192
    v_mfma_f32_16x16x32_bf16 a[40:43], a[176:179], v[128:131], a[40:43]
    v_sub_f32 v80, v10, v64
    v_sub_f32 v82, v11, v68
    v_mfma_f32_16x16x32_bf16 a[40:43], a[180:183], v[132:135], a[40:43]
    v_sub_f32 v81, v10, v66
    v_sub_f32 v83, v11, v70
    v_mfma_f32_16x16x32_bf16 a[44:47], a[184:187], v[128:131], a[44:47]
    ds_write_b128 v104, a[36:39] offset:9216
    v_mfma_f32_16x16x32_bf16 a[44:47], a[188:191], v[132:135], a[44:47]
    v_exp_f32_e64 v80, v80
    v_mfma_f32_16x16x32_bf16 v[216:219], a[192:195], v[128:131], v[216:219]
    v_exp_f32_e64 v82, v82
    v_mfma_f32_16x16x32_bf16 v[216:219], a[196:199], v[132:135], v[216:219]
    ds_write_b128 v104, a[40:43] offset:10240
    v_mfma_f32_16x16x32_bf16 v[220:223], a[200:203], v[128:131], v[220:223]
    v_exp_f32_e64 v81, v81
    v_mfma_f32_16x16x32_bf16 v[220:223], a[204:207], v[132:135], v[220:223]
    ds_write_b128 v104, a[44:47] offset:11264
    v_mfma_f32_16x16x32_bf16 v[224:227], a[208:211], v[128:131], v[224:227]
    v_exp_f32_e64 v83, v83
    v_mfma_f32_16x16x32_bf16 v[224:227], a[212:215], v[132:135], v[224:227]
    v_mul_f32 v10, v80, v65
    v_mul_f32 v11, v82, v69
    v_mfma_f32_16x16x32_bf16 v[228:231], a[216:219], v[128:131], v[228:231]
    v_fmac_f32 v10, v81, v67
    v_fmac_f32 v11, v83, v71
    v_mfma_f32_16x16x32_bf16 v[228:231], a[220:223], v[132:135], v[228:231]
    v_rcp_f32 v10, v10
    v_rcp_f32 v11, v11
    v_mul_f32 v80, v80, v10
    v_mul_f32 v82, v82, v11
    v_mul_f32 v81, v81, v10
    v_mul_f32 v83, v83, v11
    v_pk_mul_f32 v[184:185], v[184:185], v[80:81] op_sel_hi:[1,0]
    v_pk_mul_f32 v[186:187], v[186:187], v[80:81] op_sel_hi:[1,0]
    v_pk_mul_f32 v[188:189], v[188:189], v[80:81] op_sel_hi:[1,0]
    v_pk_mul_f32 v[190:191], v[190:191], v[80:81] op_sel_hi:[1,0]
    s_waitcnt lgkmcnt(9)
    s_nop 0
    v_pk_fma_f32 v[184:185], v[136:137], v[80:81], v[184:185] op_sel:[0,1,0] op_sel_hi:[1,1,1]
    v_pk_fma_f32 v[186:187], v[138:139], v[80:81], v[186:187] op_sel:[0,1,0] op_sel_hi:[1,1,1]
    v_pk_fma_f32 v[188:189], v[140:141], v[80:81], v[188:189] op_sel:[0,1,0] op_sel_hi:[1,1,1]
    v_pk_fma_f32 v[190:191], v[142:143], v[80:81], v[190:191] op_sel:[0,1,0] op_sel_hi:[1,1,1]
    v_cvt_pk_bf16_f32 v184, v184, v185
    v_cvt_pk_bf16_f32 v185, v186, v187
    v_cvt_pk_bf16_f32 v186, v188, v189
    v_cvt_pk_bf16_f32 v187, v190, v191
    s_nop 0
    v_permlane16_swap_b32 v184, v186
    v_permlane16_swap_b32_e64 v185, v187
    ds_write_b128 v76, v[184:187]
    v_pk_mul_f32 v[192:193], v[192:193], v[80:81] op_sel_hi:[1,0]
    v_pk_mul_f32 v[194:195], v[194:195], v[80:81] op_sel_hi:[1,0]
    v_pk_mul_f32 v[196:197], v[196:197], v[80:81] op_sel_hi:[1,0]
    v_pk_mul_f32 v[198:199], v[198:199], v[80:81] op_sel_hi:[1,0]
    v_pk_fma_f32 v[192:193], v[144:145], v[80:81], v[192:193] op_sel:[0,1,0] op_sel_hi:[1,1,1]
    v_pk_fma_f32 v[194:195], v[146:147], v[80:81], v[194:195] op_sel:[0,1,0] op_sel_hi:[1,1,1]
    v_pk_fma_f32 v[196:197], v[148:149], v[80:81], v[196:197] op_sel:[0,1,0] op_sel_hi:[1,1,1]
    v_pk_fma_f32 v[198:199], v[150:151], v[80:81], v[198:199] op_sel:[0,1,0] op_sel_hi:[1,1,1]
    v_cvt_pk_bf16_f32 v188, v192, v193
    v_cvt_pk_bf16_f32 v189, v194, v195
    v_cvt_pk_bf16_f32 v190, v196, v197
    v_cvt_pk_bf16_f32 v191, v198, v199
    s_nop 0
    v_permlane16_swap_b32 v188, v190
    v_permlane16_swap_b32_e64 v189, v191
    ds_write_b128 v77, v[188:191]
    v_pk_mul_f32 v[200:201], v[200:201], v[82:83] op_sel_hi:[1,0]
    v_pk_mul_f32 v[202:203], v[202:203], v[82:83] op_sel_hi:[1,0]
    v_pk_mul_f32 v[204:205], v[204:205], v[82:83] op_sel_hi:[1,0]
    v_pk_mul_f32 v[206:207], v[206:207], v[82:83] op_sel_hi:[1,0]
    s_waitcnt lgkmcnt(6)
    s_nop 0
    v_pk_fma_f32 v[200:201], v[152:153], v[82:83], v[200:201] op_sel:[0,1,0] op_sel_hi:[1,1,1]
    v_pk_fma_f32 v[202:203], v[154:155], v[82:83], v[202:203] op_sel:[0,1,0] op_sel_hi:[1,1,1]
    v_pk_fma_f32 v[204:205], v[156:157], v[82:83], v[204:205] op_sel:[0,1,0] op_sel_hi:[1,1,1]
    v_pk_fma_f32 v[206:207], v[158:159], v[82:83], v[206:207] op_sel:[0,1,0] op_sel_hi:[1,1,1]
    v_cvt_pk_bf16_f32 v200, v200, v201
    v_cvt_pk_bf16_f32 v201, v202, v203
    v_cvt_pk_bf16_f32 v202, v204, v205
    v_cvt_pk_bf16_f32 v203, v206, v207
    s_nop 0
    v_permlane16_swap_b32 v200, v202
    v_permlane16_swap_b32_e64 v201, v203
    ds_read_b128 v[192:195], v108
    ds_read_b128 v[196:199], v108 offset:1024
    ds_write_b128 v76, v[200:203] offset:2048
    v_pk_mul_f32 v[208:209], v[208:209], v[82:83] op_sel_hi:[1,0]
    v_pk_mul_f32 v[210:211], v[210:211], v[82:83] op_sel_hi:[1,0]
    v_pk_mul_f32 v[212:213], v[212:213], v[82:83] op_sel_hi:[1,0]
    v_pk_mul_f32 v[214:215], v[214:215], v[82:83] op_sel_hi:[1,0]
    v_pk_fma_f32 v[208:209], v[160:161], v[82:83], v[208:209] op_sel:[0,1,0] op_sel_hi:[1,1,1]
    v_pk_fma_f32 v[210:211], v[162:163], v[82:83], v[210:211] op_sel:[0,1,0] op_sel_hi:[1,1,1]
    v_pk_fma_f32 v[212:213], v[164:165], v[82:83], v[212:213] op_sel:[0,1,0] op_sel_hi:[1,1,1]
    v_pk_fma_f32 v[214:215], v[166:167], v[82:83], v[214:215] op_sel:[0,1,0] op_sel_hi:[1,1,1]
    v_cvt_pk_bf16_f32 v204, v208, v209
    v_cvt_pk_bf16_f32 v205, v210, v211
    v_cvt_pk_bf16_f32 v206, v212, v213
    v_cvt_pk_bf16_f32 v207, v214, v215
    s_nop 0
    v_permlane16_swap_b32 v204, v206
    v_permlane16_swap_b32_e64 v205, v207
    ds_write_b128 v77, v[204:207] offset:2048
    s_waitcnt lgkmcnt(3)
    s_nop 0
    buffer_store_dwordx4 v[192:195], v1, s[28:31], 0 offen sc1 nt
    s_waitcnt lgkmcnt(2)
    s_nop 0
    buffer_store_dwordx4 v[196:199], v1, s[28:31], 0 offen offset:2048 sc1 nt
    s_barrier
    s_nop 0
    ds_read_b64 v[74:75], v107 offset:13312
    ds_read_b128 v[168:171], v106 offset:8192
    ds_read_b128 v[172:175], v106 offset:9216
    ds_read_b128 v[176:179], v106 offset:10240
    ds_read_b128 v[180:183], v106 offset:11264
    ds_read_b128 v[208:211], v108 offset:2048
    ds_read_b128 v[212:215], v108 offset:3072
    s_waitcnt lgkmcnt(6)
    v_min_f32 v12, v72, v74
    v_sub_f32 v84, v12, v72
    v_sub_f32 v85, v12, v74
    v_exp_f32 v84, v84
    v_exp_f32 v85, v85
    v_mul_f32 v12, v84, v73
    v_fmac_f32 v12, v85, v75
    v_rcp_f32 v12, v12
    s_nop 0
    v_mul_f32 v84, v84, v12
    v_mul_f32 v85, v85, v12
    v_pk_mul_f32 v[216:217], v[216:217], v[84:85] op_sel_hi:[1,0]
    v_pk_mul_f32 v[218:219], v[218:219], v[84:85] op_sel_hi:[1,0]
    v_pk_mul_f32 v[220:221], v[220:221], v[84:85] op_sel_hi:[1,0]
    v_pk_mul_f32 v[222:223], v[222:223], v[84:85] op_sel_hi:[1,0]
    v_pk_mul_f32 v[224:225], v[224:225], v[84:85] op_sel_hi:[1,0]
    v_pk_mul_f32 v[226:227], v[226:227], v[84:85] op_sel_hi:[1,0]
    v_pk_mul_f32 v[228:229], v[228:229], v[84:85] op_sel_hi:[1,0]
    v_pk_mul_f32 v[230:231], v[230:231], v[84:85] op_sel_hi:[1,0]
    s_waitcnt lgkmcnt(2)
    s_nop 0
    v_pk_fma_f32 v[216:217], v[168:169], v[84:85], v[216:217] op_sel:[0,1,0] op_sel_hi:[1,1,1]
    v_pk_fma_f32 v[218:219], v[170:171], v[84:85], v[218:219] op_sel:[0,1,0] op_sel_hi:[1,1,1]
    v_pk_fma_f32 v[220:221], v[172:173], v[84:85], v[220:221] op_sel:[0,1,0] op_sel_hi:[1,1,1]
    v_pk_fma_f32 v[222:223], v[174:175], v[84:85], v[222:223] op_sel:[0,1,0] op_sel_hi:[1,1,1]
    v_cvt_pk_bf16_f32 v216, v216, v217
    v_cvt_pk_bf16_f32 v217, v218, v219
    v_cvt_pk_bf16_f32 v218, v220, v221
    v_cvt_pk_bf16_f32 v219, v222, v223
    s_nop 0
    v_permlane16_swap_b32 v216, v218
    v_permlane16_swap_b32_e64 v217, v219
    ds_write_b128 v76, v[216:219] offset:4096
    s_waitcnt lgkmcnt(2)
    s_nop 0
    buffer_store_dwordx4 v[208:211], v1, s[28:31], s93 offen sc1 nt
    s_waitcnt lgkmcnt(1)
    s_nop 0
    buffer_store_dwordx4 v[212:215], v1, s[28:31], s93 offen offset:2048 sc1 nt
    v_pk_fma_f32 v[224:225], v[176:177], v[84:85], v[224:225] op_sel:[0,1,0] op_sel_hi:[1,1,1]
    v_pk_fma_f32 v[226:227], v[178:179], v[84:85], v[226:227] op_sel:[0,1,0] op_sel_hi:[1,1,1]
    v_pk_fma_f32 v[228:229], v[180:181], v[84:85], v[228:229] op_sel:[0,1,0] op_sel_hi:[1,1,1]
    v_pk_fma_f32 v[230:231], v[182:183], v[84:85], v[230:231] op_sel:[0,1,0] op_sel_hi:[1,1,1]
    v_cvt_pk_bf16_f32 v220, v224, v225
    v_cvt_pk_bf16_f32 v221, v226, v227
    v_cvt_pk_bf16_f32 v222, v228, v229
    v_cvt_pk_bf16_f32 v223, v230, v231
    s_nop 0
    v_permlane16_swap_b32 v220, v222
    v_permlane16_swap_b32_e64 v221, v223
    ds_write_b128 v77, v[220:223] offset:4096
    ds_read_b128 v[224:227], v108 offset:4096
    ds_read_b128 v[228:231], v108 offset:5120
    s_waitcnt lgkmcnt(1)
    s_nop 0
    buffer_store_dwordx4 v[224:227], v1, s[28:31], s94 offen sc1 nt
    s_waitcnt lgkmcnt(0)
    s_nop 0
    buffer_store_dwordx4 v[228:231], v1, s[28:31], s94 offen offset:2048 sc1 nt
L_end:
    s_endpgm
L_code_end:
L_stub3:
    s_call_b64 s[58:59], L_rare0
    s_branch L_back3
L_stub4:
    s_call_b64 s[58:59], L_rare1
    s_branch L_back4
L_stub5:
    s_call_b64 s[58:59], L_rare2
    s_branch L_back5
L_stub6:
    s_call_b64 s[58:59], L_rare0
    s_branch L_back6
L_stub7:
    s_call_b64 s[58:59], L_rare1
    s_branch L_back7
L_stub8:
    s_call_b64 s[58:59], L_rare2
    s_branch L_back8
L_stub9:
    s_call_b64 s[58:59], L_rare0
    s_branch L_back9
L_stub10:
    s_call_b64 s[58:59], L_rare1
    s_branch L_back10
L_stub11:
    s_call_b64 s[58:59], L_rare2
    s_branch L_back11
L_stub12:
    s_call_b64 s[58:59], L_rare0
    s_branch L_back12
L_stub13:
    s_call_b64 s[58:59], L_rare1
    s_branch L_back13
L_stub14:
    s_call_b64 s[58:59], L_rare2
    s_branch L_back14
L_stub15:
    s_call_b64 s[58:59], L_rare0
    s_branch L_back15
L_stub16:
    s_call_b64 s[58:59], L_rare1
    s_branch L_back16
L_stub17:
    s_call_b64 s[58:59], L_rare2
    s_branch L_back17
L_stub18:
    s_call_b64 s[58:59], L_rare0
    s_branch L_back18
L_stub19:
    s_call_b64 s[58:59], L_rare1
    s_branch L_back19
L_stub20:
    s_call_b64 s[58:59], L_rare2
    s_branch L_back20
L_stub21:
    s_call_b64 s[58:59], L_rare0
    s_branch L_back21
L_stub22:
    s_call_b64 s[58:59], L_rare1
    s_branch L_back22
L_stub23:
    s_call_b64 s[58:59], L_rare2
    s_branch L_back23
L_rare0:
    s_nop 15
    v_max3_f32 v10, v16, v17, v18
    v_max3_f32 v11, v19, v20, v21
    v_max3_f32 v10, v10, v22, v23
    v_max3_f32 v11, v11, v24, v25
    v_max3_f32 v10, v10, v26, v27
    v_max3_f32 v11, v11, v28, v29
    v_max3_f32 v10, v10, v30, v31
    v_max3_f32 v10, v10, v11, 0
    v_mov_b32 v11, v10
    s_nop 1
    v_permlane32_swap_b32 v10, v11
    v_max_f32 v10, v10, v11
    v_mov_b32 v11, v10
    s_nop 1
    v_permlane16_swap_b32 v10, v11
    v_max_f32 v10, v10, v11
    v_sub_f32 v11, 0, v10
    v_exp_f32 v11, v11
    v_sub_f32 v64, v64, v10
    v_sub_f32 v65, v65, v10
    v_sub_f32 v66, v66, v10
    v_sub_f32 v67, v67, v10
    v_mul_f32 v100, v100, v11
    v_mul_f32 v184, v184, v11
    v_mul_f32 v185, v185, v11
    v_mul_f32 v186, v186, v11
    v_mul_f32 v187, v187, v11
    v_mul_f32 v188, v188, v11
    v_mul_f32 v189, v189, v11
    v_mul_f32 v190, v190, v11
    v_mul_f32 v191, v191, v11
    v_mul_f32 v192, v192, v11
    v_mul_f32 v193, v193, v11
    v_mul_f32 v194, v194, v11
    v_mul_f32 v195, v195, v11
    v_mul_f32 v196, v196, v11
    v_mul_f32 v197, v197, v11
    v_mul_f32 v198, v198, v11
    v_mul_f32_e64 v199, v199, v11
    v_accvgpr_read_b32 v12, a0
    v_mul_f32_e64 v12, v12, v11
    v_accvgpr_write_b32 a0, v12
    v_accvgpr_read_b32 v12, a1
    v_mul_f32_e64 v12, v12, v11
    v_accvgpr_write_b32 a1, v12
    v_accvgpr_read_b32 v12, a2
    v_mul_f32_e64 v12, v12, v11
    v_accvgpr_write_b32 a2, v12
    v_accvgpr_read_b32 v12, a3
    v_mul_f32_e64 v12, v12, v11
    v_accvgpr_write_b32 a3, v12
    v_accvgpr_read_b32 v12, a4
    v_mul_f32_e64 v12, v12, v11
    v_accvgpr_write_b32 a4, v12
    v_accvgpr_read_b32 v12, a5
    v_mul_f32_e64 v12, v12, v11
    v_accvgpr_write_b32 a5, v12
    v_accvgpr_read_b32 v12, a6
    v_mul_f32_e64 v12, v12, v11
    v_accvgpr_write_b32 a6, v12
    v_accvgpr_read_b32 v12, a7
    v_mul_f32_e64 v12, v12, v11
    v_accvgpr_write_b32 a7, v12
    v_accvgpr_read_b32 v12, a8
    v_mul_f32_e64 v12, v12, v11
    v_accvgpr_write_b32 a8, v12
    v_accvgpr_read_b32 v12, a9
    v_mul_f32_e64 v12, v12, v11
    v_accvgpr_write_b32 a9, v12
    v_accvgpr_read_b32 v12, a10
    v_mul_f32_e64 v12, v12, v11
    v_accvgpr_write_b32 a10, v12
    v_accvgpr_read_b32 v12, a11
    v_mul_f32_e64 v12, v12, v11
    v_accvgpr_write_b32 a11, v12
    v_accvgpr_read_b32 v12, a12
    v_mul_f32_e64 v12, v12, v11
    v_accvgpr_write_b32 a12, v12
    v_accvgpr_read_b32 v12, a13
    v_mul_f32_e64 v12, v12, v11
    v_accvgpr_write_b32 a13, v12
    v_accvgpr_read_b32 v12, a14
    v_mul_f32_e64 v12, v12, v11
    v_accvgpr_write_b32 a14, v12
    v_accvgpr_read_b32 v12, a15
    v_mul_f32_e64 v12, v12, v11
    v_accvgpr_write_b32 a15, v12
    v_sub_f32 v16, v16, v10
    v_sub_f32 v17, v17, v10
    v_sub_f32 v18, v18, v10
    v_sub_f32 v19, v19, v10
    v_sub_f32 v20, v20, v10
    v_sub_f32 v21, v21, v10
    v_sub_f32 v22, v22, v10
    v_sub_f32 v23, v23, v10
    v_sub_f32 v24, v24, v10
    v_sub_f32 v25, v25, v10
    v_sub_f32 v26, v26, v10
    v_sub_f32 v27, v27, v10
    v_sub_f32 v28, v28, v10
    v_sub_f32 v29, v29, v10
    v_sub_f32 v30, v30, v10
    v_sub_f32 v31, v31, v10
    v_exp_f32 v16, v16
    v_exp_f32 v17, v17
    v_exp_f32 v18, v18
    v_exp_f32 v19, v19
    v_exp_f32 v20, v20
    v_exp_f32 v21, v21
    v_exp_f32 v22, v22
    v_exp_f32 v23, v23
    v_exp_f32 v24, v24
    v_exp_f32 v25, v25
    v_exp_f32 v26, v26
    v_exp_f32 v27, v27
    v_exp_f32 v28, v28
    v_exp_f32 v29, v29
    v_exp_f32 v30, v30
    v_exp_f32 v31, v31
    v_cvt_pk_bf16_f32 v112, v16, v17
    v_cvt_pk_bf16_f32 v113, v18, v19
    v_cvt_pk_bf16_f32 v114, v20, v21
    v_cvt_pk_bf16_f32 v115, v22, v23
    v_cvt_pk_bf16_f32 v116, v24, v25
    v_cvt_pk_bf16_f32 v117, v26, v27
    v_cvt_pk_bf16_f32 v118, v28, v29
    v_cvt_pk_bf16_f32 v119, v30, v31
    v_mfma_f32_16x16x32_bf16 v[88:91], v[96:99], v[112:115], 0
    s_nop 0
    s_nop 0
    v_mfma_f32_16x16x32_bf16 v[88:91], v[96:99], v[116:119], v[88:91]
    s_nop 9
    s_setpc_b64 s[58:59]
L_rare1:
    s_nop 15
    s_nop 0
    v_max3_f32 v10, v32, v33, v34
    v_max3_f32 v11, v35, v36, v37
    v_max3_f32 v10, v10, v38, v39
    v_max3_f32 v11, v11, v40, v41
    v_max3_f32 v10, v10, v42, v43
    v_max3_f32 v11, v11, v44, v45
    v_max3_f32 v10, v10, v46, v47
    v_max3_f32 v10, v10, v11, 0
    v_mov_b32 v11, v10
    s_nop 1
    v_permlane32_swap_b32 v10, v11
    v_max_f32 v10, v10, v11
    v_mov_b32 v11, v10
    s_nop 1
    v_permlane16_swap_b32 v10, v11
    v_max_f32 v10, v10, v11
    v_sub_f32 v11, 0, v10
    v_exp_f32 v11, v11
    v_sub_f32 v68, v68, v10
    v_sub_f32 v69, v69, v10
    v_sub_f32 v70, v70, v10
    v_sub_f32 v71, v71, v10
    v_mul_f32 v101, v101, v11
    v_mul_f32 v200, v200, v11
    v_mul_f32 v201, v201, v11
    v_mul_f32 v202, v202, v11
    v_mul_f32 v203, v203, v11
    v_mul_f32 v204, v204, v11
    v_mul_f32 v205, v205, v11
    v_mul_f32 v206, v206, v11
    v_mul_f32 v207, v207, v11
    v_mul_f32 v208, v208, v11
    v_mul_f32 v209, v209, v11
    v_mul_f32 v210, v210, v11
    v_mul_f32 v211, v211, v11
    v_mul_f32 v212, v212, v11
    v_mul_f32 v213, v213, v11
    v_mul_f32 v214, v214, v11
    v_mul_f32_e64 v215, v215, v11
    v_accvgpr_read_b32 v12, a16
    v_mul_f32_e64 v12, v12, v11
    v_accvgpr_write_b32 a16, v12
    v_accvgpr_read_b32 v12, a17
    v_mul_f32_e64 v12, v12, v11
    v_accvgpr_write_b32 a17, v12
    v_accvgpr_read_b32 v12, a18
    v_mul_f32_e64 v12, v12, v11
    v_accvgpr_write_b32 a18, v12
    v_accvgpr_read_b32 v12, a19
    v_mul_f32_e64 v12, v12, v11
    v_accvgpr_write_b32 a19, v12
    v_accvgpr_read_b32 v12, a20
    v_mul_f32_e64 v12, v12, v11
    v_accvgpr_write_b32 a20, v12
    v_accvgpr_read_b32 v12, a21
    v_mul_f32_e64 v12, v12, v11
    v_accvgpr_write_b32 a21, v12
    v_accvgpr_read_b32 v12, a22
    v_mul_f32_e64 v12, v12, v11
    v_accvgpr_write_b32 a22, v12
    v_accvgpr_read_b32 v12, a23
    v_mul_f32_e64 v12, v12, v11
    v_accvgpr_write_b32 a23, v12
    v_accvgpr_read_b32 v12, a24
    v_mul_f32_e64 v12, v12, v11
    v_accvgpr_write_b32 a24, v12
    v_accvgpr_read_b32 v12, a25
    v_mul_f32_e64 v12, v12, v11
    v_accvgpr_write_b32 a25, v12
    v_accvgpr_read_b32 v12, a26
    v_mul_f32_e64 v12, v12, v11
    v_accvgpr_write_b32 a26, v12
    v_accvgpr_read_b32 v12, a27
    v_mul_f32_e64 v12, v12, v11
    v_accvgpr_write_b32 a27, v12
    v_accvgpr_read_b32 v12, a28
    v_mul_f32_e64 v12, v12, v11
    v_accvgpr_write_b32 a28, v12
    v_accvgpr_read_b32 v12, a29
    v_mul_f32_e64 v12, v12, v11
    v_accvgpr_write_b32 a29, v12
    v_accvgpr_read_b32 v12, a30
    v_mul_f32_e64 v12, v12, v11
    v_accvgpr_write_b32 a30, v12
    v_accvgpr_read_b32 v12, a31
    v_mul_f32_e64 v12, v12, v11
    v_accvgpr_write_b32 a31, v12
    v_sub_f32 v32, v32, v10
    v_sub_f32 v33, v33, v10
    v_sub_f32 v34, v34, v10
    v_sub_f32 v35, v35, v10
    v_sub_f32 v36, v36, v10
    v_sub_f32 v37, v37, v10
    v_sub_f32 v38, v38, v10
    v_sub_f32 v39, v39, v10
    v_sub_f32 v40, v40, v10
    v_sub_f32 v41, v41, v10
    v_sub_f32 v42, v42, v10
    v_sub_f32 v43, v43, v10
    v_sub_f32 v44, v44, v10
    v_sub_f32 v45, v45, v10
    v_sub_f32 v46, v46, v10
    v_sub_f32 v47, v47, v10
    v_exp_f32 v32, v32
    v_exp_f32 v33, v33
    v_exp_f32 v34, v34
    v_exp_f32 v35, v35
    v_exp_f32 v36, v36
    v_exp_f32 v37, v37
    v_exp_f32 v38, v38
    v_exp_f32 v39, v39
    v_exp_f32 v40, v40
    v_exp_f32 v41, v41
    v_exp_f32 v42, v42
    v_exp_f32 v43, v43
    v_exp_f32 v44, v44
    v_exp_f32 v45, v45
    v_exp_f32 v46, v46
    v_exp_f32 v47, v47
    v_cvt_pk_bf16_f32 v120, v32, v33
    v_cvt_pk_bf16_f32 v121, v34, v35
    v_cvt_pk_bf16_f32 v122, v36, v37
    v_cvt_pk_bf16_f32 v123, v38, v39
    v_cvt_pk_bf16_f32 v124, v40, v41
    v_cvt_pk_bf16_f32 v125, v42, v43
    v_cvt_pk_bf16_f32 v126, v44, v45
    v_cvt_pk_bf16_f32 v127, v46, v47
    v_mfma_f32_16x16x32_bf16 v[88:91], v[96:99], v[120:123], 0
    s_nop 0
    s_nop 0
    v_mfma_f32_16x16x32_bf16 v[88:91], v[96:99], v[124:127], v[88:91]
    s_nop 9
    s_setpc_b64 s[58:59]
L_rare2:
    s_nop 15
    s_nop 0
    v_max3_f32 v10, v48, v49, v50
    v_max3_f32 v11, v51, v52, v53
    v_max3_f32 v10, v10, v54, v55
    v_max3_f32 v11, v11, v56, v57
    v_max3_f32 v10, v10, v58, v59
    v_max3_f32 v11, v11, v60, v61
    v_max3_f32 v10, v10, v62, v63
    v_max3_f32 v10, v10, v11, 0
    v_mov_b32 v11, v10
    s_nop 1
    v_permlane32_swap_b32 v10, v11
    v_max_f32 v10, v10, v11
    v_mov_b32 v11, v10
    s_nop 1
    v_permlane16_swap_b32 v10, v11
    v_max_f32 v10, v10, v11
    v_sub_f32 v11, 0, v10
    v_exp_f32 v11, v11
    v_sub_f32 v72, v72, v10
    v_sub_f32 v73, v73, v10
    v_sub_f32 v74, v74, v10
    v_sub_f32 v75, v75, v10
    v_mul_f32 v102, v102, v11
    v_mul_f32 v216, v216, v11
    v_mul_f32 v217, v217, v11
    v_mul_f32 v218, v218, v11
    v_mul_f32 v219, v219, v11
    v_mul_f32 v220, v220, v11
    v_mul_f32 v221, v221, v11
    v_mul_f32 v222, v222, v11
    v_mul_f32 v223, v223, v11
    v_mul_f32 v224, v224, v11
    v_mul_f32 v225, v225, v11
    v_mul_f32 v226, v226, v11
    v_mul_f32 v227, v227, v11
    v_mul_f32 v228, v228, v11
    v_mul_f32 v229, v229, v11
    v_mul_f32 v230, v230, v11
    v_mul_f32_e64 v231, v231, v11
    v_accvgpr_read_b32 v12, a32
    v_mul_f32_e64 v12, v12, v11
    v_accvgpr_write_b32 a32, v12
    v_accvgpr_read_b32 v12, a33
    v_mul_f32_e64 v12, v12, v11
    v_accvgpr_write_b32 a33, v12
    v_accvgpr_read_b32 v12, a34
    v_mul_f32_e64 v12, v12, v11
    v_accvgpr_write_b32 a34, v12
    v_accvgpr_read_b32 v12, a35
    v_mul_f32_e64 v12, v12, v11
    v_accvgpr_write_b32 a35, v12
    v_accvgpr_read_b32 v12, a36
    v_mul_f32_e64 v12, v12, v11
    v_accvgpr_write_b32 a36, v12
    v_accvgpr_read_b32 v12, a37
    v_mul_f32_e64 v12, v12, v11
    v_accvgpr_write_b32 a37, v12
    v_accvgpr_read_b32 v12, a38
    v_mul_f32_e64 v12, v12, v11
    v_accvgpr_write_b32 a38, v12
    v_accvgpr_read_b32 v12, a39
    v_mul_f32_e64 v12, v12, v11
    v_accvgpr_write_b32 a39, v12
    v_accvgpr_read_b32 v12, a40
    v_mul_f32_e64 v12, v12, v11
    v_accvgpr_write_b32 a40, v12
    v_accvgpr_read_b32 v12, a41
    v_mul_f32_e64 v12, v12, v11
    v_accvgpr_write_b32 a41, v12
    v_accvgpr_read_b32 v12, a42
    v_mul_f32_e64 v12, v12, v11
    v_accvgpr_write_b32 a42, v12
    v_accvgpr_read_b32 v12, a43
    v_mul_f32_e64 v12, v12, v11
    v_accvgpr_write_b32 a43, v12
    v_accvgpr_read_b32 v12, a44
    v_mul_f32_e64 v12, v12, v11
    v_accvgpr_write_b32 a44, v12
    v_accvgpr_read_b32 v12, a45
    v_mul_f32_e64 v12, v12, v11
    v_accvgpr_write_b32 a45, v12
    v_accvgpr_read_b32 v12, a46
    v_mul_f32_e64 v12, v12, v11
    v_accvgpr_write_b32 a46, v12
    v_accvgpr_read_b32 v12, a47
    v_mul_f32_e64 v12, v12, v11
    v_accvgpr_write_b32 a47, v12
    v_sub_f32 v48, v48, v10
    v_sub_f32 v49, v49, v10
    v_sub_f32 v50, v50, v10
    v_sub_f32 v51, v51, v10
    v_sub_f32 v52, v52, v10
    v_sub_f32 v53, v53, v10
    v_sub_f32 v54, v54, v10
    v_sub_f32 v55, v55, v10
    v_sub_f32 v56, v56, v10
    v_sub_f32 v57, v57, v10
    v_sub_f32 v58, v58, v10
    v_sub_f32 v59, v59, v10
    v_sub_f32 v60, v60, v10
    v_sub_f32 v61, v61, v10
    v_sub_f32 v62, v62, v10
    v_sub_f32 v63, v63, v10
    v_exp_f32 v48, v48
    v_exp_f32 v49, v49
    v_exp_f32 v50, v50
    v_exp_f32 v51, v51
    v_exp_f32 v52, v52
    v_exp_f32 v53, v53
    v_exp_f32 v54, v54
    v_exp_f32 v55, v55
    v_exp_f32 v56, v56
    v_exp_f32 v57, v57
    v_exp_f32 v58, v58
    v_exp_f32 v59, v59
    v_exp_f32 v60, v60
    v_exp_f32 v61, v61
    v_exp_f32 v62, v62
    v_exp_f32 v63, v63
    v_cvt_pk_bf16_f32 v128, v48, v49
    v_cvt_pk_bf16_f32 v129, v50, v51
    v_cvt_pk_bf16_f32 v130, v52, v53
    v_cvt_pk_bf16_f32 v131, v54, v55
    v_cvt_pk_bf16_f32 v132, v56, v57
    v_cvt_pk_bf16_f32 v133, v58, v59
    v_cvt_pk_bf16_f32 v134, v60, v61
    v_cvt_pk_bf16_f32 v135, v62, v63
    v_mfma_f32_16x16x32_bf16 v[88:91], v[96:99], v[128:131], 0
    s_nop 0
    s_nop 0
    v_mfma_f32_16x16x32_bf16 v[88:91], v[96:99], v[132:135], v[88:91]
    s_nop 9
    s_setpc_b64 s[58:59]
L_all_end:
.section .rodata,"a"
.p2align 6
.amdhsa_kernel standalone__gqa_softmax__near_ridge_kernel
  .amdhsa_next_free_vgpr 512
  .amdhsa_next_free_sgpr 102
  .amdhsa_accum_offset 256
  .amdhsa_group_segment_fixed_size 0
  .amdhsa_kernarg_size 48
  .amdhsa_user_sgpr_count 2
  .amdhsa_user_sgpr_kernarg_segment_ptr 1
  .amdhsa_system_sgpr_workgroup_id_x 1
.end_amdhsa_kernel
```
